```python
import torch

def _softmax(x, axis=-1):
    return torch.softmax(x, dim=axis)
def _gelu(x):
    return torch.nn.functional.gelu(x, approximate="tanh")
def _silu(x):
    return torch.nn.functional.silu(x)
def _sigmoid(x):
    return torch.sigmoid(x)
def _layernorm(x, axis=-1, eps=1e-5):
    m = x.mean(dim=axis, keepdim=True)
    v = x.var(dim=axis, keepdim=True, unbiased=False)
    return (x - m) / torch.sqrt(v + eps)
def _scatter_add(tgt, idx, src, axis=0):
    return tgt.clone().index_add_(axis, idx, src)
def _segment_sum(src, seg, n):
    out = torch.zeros((n,) + src.shape[1:], dtype=src.dtype)
    return out.index_add_(0, seg, src)
def _pad(x, pw):
    flat = tuple(v for pair in reversed(pw) for v in pair)
    return torch.nn.functional.pad(x, flat)

kernel_name = 'interleave_layers__linear_kernel_hedgehog__sliding_local_dilated__prompt'

def setup_inputs():

    _w = (lambda a: (lambda t: t.to(torch.bfloat16) if t.is_floating_point() else t)(torch.as_tensor(a)))
    def _A_setup():
        B, S, D, H = 1, 2048, 1024, 32
        Dh = D // H
        return {
            "x": _w((lambda *s: torch.randn(*s, dtype=torch.bfloat16) * 0.05)(B, S, D)),
            "wqkv": _w((lambda *s: torch.randn(*s, dtype=torch.bfloat16) * 0.2)(D, 3 * D)),
            "w_phi": _w((lambda *s: torch.randn(*s, dtype=torch.bfloat16) * 0.2)(H, Dh, Dh) * (Dh ** -0.5)),
            "wo": _w((lambda *s: torch.randn(*s, dtype=torch.bfloat16) * 0.05)(D, D)),
        }
    _A_in = _A_setup()

    def _B_setup():
        B, S, D = 1, 2048, 1024
        return {
            "x": _w((lambda *s: torch.randn(*s, dtype=torch.bfloat16) * 0.05)(B, S, D)),
            "wqkv": _w((lambda *s: torch.randn(*s, dtype=torch.bfloat16) * 0.1)(D, 3 * D)),
            "wo": _w((lambda *s: torch.randn(*s, dtype=torch.bfloat16) * 0.05)(D, D)),
        }
    _B_in = _B_setup()

    return {
        "A_x": _A_in["x"],
        "A_wqkv": _A_in["wqkv"],
        "A_w_phi": _A_in["w_phi"],
        "A_wo": _A_in["wo"],
        "B_x": _B_in["x"],
        "B_wqkv": _B_in["wqkv"],
        "B_wo": _B_in["wo"],
    }

def reference(A_x, A_wqkv, A_w_phi, A_wo, B_x, B_wqkv, B_wo):
    def _A_ref(x, wqkv, w_phi, wo):
        B, S, D = x.shape
        H = 32; Dh = D // H
        qkv = (lambda x, *d: x.permute(*d))((x @ wqkv).reshape(B, S, 3, H, Dh), 2, 0, 3, 1, 4)
        q, k, v = qkv[0], qkv[1], qkv[2]
        pq = torch.einsum("bhsd,hdf->bhsf", q, w_phi)
        pk = torch.einsum("bhsd,hdf->bhsf", k, w_phi)
        phi_q = torch.concatenate([_softmax(pq, axis=-1), _softmax(-pq, axis=-1)], axis=-1)
        phi_k = torch.concatenate([_softmax(pk, axis=-1), _softmax(-pk, axis=-1)], axis=-1)
        kv = torch.einsum("bhsf,bhsd->bhfd", phi_k, v)
        z  = torch.einsum("bhsf->bhf", phi_k)
        num = torch.einsum("bhqf,bhfd->bhqd", phi_q, kv)
        den = torch.einsum("bhqf,bhf->bhq", phi_q, z)[..., None] + 1e-6
        o = num / den
        return (lambda x, *d: x.permute(*d))(o, 0, 2, 1, 3).reshape(B, S, D) @ wo

    def _B_ref(x, wqkv, wo):
        B, S, D = x.shape
        H = 32; Dh = D // H
        W, dil = 8, 2
        qkv = (lambda x, *d: x.permute(*d))((x @ wqkv).reshape(B, S, 3, H, Dh), 2, 0, 3, 1, 4)
        q, k, v = qkv[0], qkv[1], qkv[2]
        scale = Dh ** -0.5
        pos = torch.arange(S)
        off = torch.arange(W) * dil
        idx = pos[:, None] - off[None, :]
        mask = idx >= 0
        idx_c = torch.where(mask, idx, 0).reshape(-1)
        kg = k[:, :, idx_c, :].reshape(B, H, S, W, Dh)
        vg = v[:, :, idx_c, :].reshape(B, H, S, W, Dh)
        logits = torch.einsum("bhsd,bhswd->bhsw", q, kg) * scale
        logits = torch.where(mask[None, None, :, :], logits, -1e9)
        attn = _softmax(logits, axis=-1)
        o = torch.einsum("bhsw,bhswd->bhsd", attn, vg)
        return (lambda x, *d: x.permute(*d))(o, 0, 2, 1, 3).reshape(B, S, D) @ wo

    x = A_x
    x = x + _A_ref(_layernorm(x, axis=-1), A_wqkv, A_w_phi, A_wo)
    x = x + _B_ref(_layernorm(x, axis=-1), B_wqkv, B_wo)
    x = x + _A_ref(_layernorm(x, axis=-1), A_wqkv, A_w_phi, A_wo)
    x = x + _B_ref(_layernorm(x, axis=-1), B_wqkv, B_wo)
    return x
```

```asm
; @launch grid=(256,1,1) block=(512,1,1) lds=163840
.amdgcn_target "amdgcn-amd-amdhsa--gfx950"
.text
.globl interleave_layers__linear_kernel_hedgehog__sliding_local_dilated__prompt_kernel
.p2align 8
.type interleave_layers__linear_kernel_hedgehog__sliding_local_dilated__prompt_kernel,@function
interleave_layers__linear_kernel_hedgehog__sliding_local_dilated__prompt_kernel:
    s_cmp_ge_u32 s2, 256
    s_cbranch_scc1 L_end
    s_load_dwordx16 s[4:19], s[0:1], 0
    s_load_dwordx4 s[20:23], s[0:1], 64
    v_lshrrev_b32 v2, 6, v0
    s_nop 0
    v_readfirstlane_b32 s50, v2
    v_and_b32 v1, 63, v0
    s_and_b32 s64, s2, 3
    s_lshl_b32 s64, s64, 2
    s_bfe_u32 s52, s2, 0x20003
    s_add_u32 s48, s64, s52
    s_mov_b32 s64, s48
    s_and_b32 s95, s2, 4
    s_lshl_b32 s95, s95, 1
    s_lshr_b32 s49, s2, 5
    s_add_u32 s49, s49, s95
    s_mov_b32 s51, 0
    s_mov_b32 s3, 0
    s_mov_b32 s26, 41943040
    s_mov_b32 s27, 0x20000
    s_mov_b32 s30, 4194304
    s_mov_b32 s31, 0x20000
    s_mov_b32 s34, 6291456
    s_mov_b32 s35, 0x20000
    s_mov_b32 s38, 2097152
    s_mov_b32 s39, 0x20000
    s_mov_b32 s42, 41943040
    s_mov_b32 s43, 0x20000
    s_mov_b32 s46, 256
    s_mov_b32 s47, 0x20000
    s_cmp_ge_u32 s50, 6
    s_cbranch_scc1 L_helper
    s_cmp_ge_u32 s50, 4
    s_cbranch_scc1 L_loader
    v_lshrrev_b32 v208, 4, v1
    v_and_b32 v209, 15, v1
    v_and_b32 v210, 1, v208
    v_lshrrev_b32 v211, 1, v208
    v_lshl_add_u32 v210, v210, 1, v211
    v_lshlrev_b32 v3, 11, v209
    v_lshl_add_u32 v3, v210, 4, v3
    s_lshl_b32 s52, s48, 18
    s_lshl_b32 s61, s50, 16
    s_add_u32 s52, s52, s61
    s_lshl_b32 s61, s49, 7
    s_add_u32 s52, s52, s61
    s_add_u32 s53, s52, 32768
    s_waitcnt lgkmcnt(0)
    s_mov_b64 s[24:25], s[22:23]
    s_mov_b64 s[28:29], s[4:5]
    s_mov_b64 s[32:33], s[6:7]
    s_mov_b64 s[36:37], s[10:11]
    s_mov_b64 s[40:41], s[22:23]
    s_mov_b64 s[44:45], s[20:21]
    buffer_load_dwordx4 v[16:19], v3, s[28:31], s52 offen offset:0
    buffer_load_dwordx4 v[20:23], v3, s[28:31], s52 offen offset:64
    buffer_load_dwordx4 v[24:27], v3, s[28:31], s53 offen offset:0
    buffer_load_dwordx4 v[28:31], v3, s[28:31], s53 offen offset:64
    s_lshr_b32 s65, s50, 1
    s_and_b32 s66, s50, 1
    v_mov_b32 v0, 1
    v_lshl_add_u32 v4, v210, 4, v209
    v_lshlrev_b32 v4, 4, v4
    v_mov_b32 v15, v4
    v_lshlrev_b32 v2, 4, v1
    v_lshlrev_b32 v14, 2, v1
    s_lshl_b32 s52, s65, 8
    s_add_u32 s52, s52, 0x26000
    v_lshl_add_u32 v5, v209, 2, s52
    v_lshl_add_u32 v6, v208, 4, s52
    v_and_b32 v211, 31, v1
    v_lshl_add_u32 v7, v211, 2, s52
    s_lshl_b32 s52, s66, 7
    s_add_u32 s52, s52, 0x26400
    v_lshl_add_u32 v8, v208, 4, s52
    v_lshl_add_u32 v9, v209, 2, s52
    s_mov_b32 s69, 40960
    s_mov_b32 s70, 0x3f803f80
    v_lshrrev_b32 v210, 1, v209
    v_xor_b32 v210, v210, v208
    s_lshl_b32 s52, s65, 13
    s_add_u32 s52, s52, 0x6000
    v_lshl_add_u32 v209, v209, 7, s52
    v_xor_b32 v211, 0, v210
    v_lshl_add_u32 v10, v211, 4, v209
    v_xor_b32 v211, 4, v210
    v_lshl_add_u32 v11, v211, 4, v209
    s_lshl_b32 s85, s48, 14
    s_lshl_b32 s61, s49, 10
    s_add_u32 s85, s85, s61
    s_lshl_b32 s61, s50, 8
    s_add_u32 s85, s85, s61
    s_add_u32 s85, s85, 0x200000
    v_lshrrev_b32 v210, 4, v1
    v_bfe_u32 v208, v1, 2, 2
    v_lshl_add_u32 v209, v210, 3, v208
    v_lshrrev_b32 v208, 1, v208
    v_and_b32 v210, 1, v210
    v_lshl_add_u32 v208, v210, 1, v208
    s_lshl_b32 s52, s66, 1
    v_xor_b32 v208, s52, v208
    v_and_b32 v210, 3, v1
    v_lshlrev_b32 v210, 3, v210
    v_lshl_add_u32 v210, v209, 7, v210
    v_xor_b32 v209, 0, v208
    v_lshl_add_u32 v12, v209, 5, v210
    v_xor_b32 v209, 1, v208
    v_lshl_add_u32 v13, v209, 5, v210
    v_lshrrev_b32 v208, 5, v1
    v_bfe_u32 v209, v1, 2, 2
    v_lshl_add_u32 v209, v208, 3, v209
    v_bfe_u32 v210, v1, 4, 1
    v_and_b32 v211, 3, v1
    v_lshlrev_b32 v212, 3, v211
    v_lshl_add_u32 v210, v210, 5, v212
    s_lshl_b32 s52, s66, 11
    s_add_u32 s52, s52, 0x26c00
    v_lshl_add_u32 v212, v209, 6, v210
    v_add_u32 v248, s52, v212
    s_mul_i32 s54, s50, 5120
    v_mul_u32_u24 v209, 136, v209
    v_add3_u32 v209, v209, v210, s54
    s_lshl_b32 s53, s65, 6
    v_add_u32 v250, s53, v209
    s_xor_b32 s55, s53, 64
    v_add_u32 v251, s55, v209
    v_and_b32 v212, 31, v1
    v_mul_u32_u24 v212, 136, v212
    v_lshl_add_u32 v212, v208, 3, v212
    v_add_u32 v249, s54, v212
    v_add_u32 v253, s54, v2
    s_xor_b32 s52, s50, 2
    s_mul_i32 s52, s52, 5120
    v_add_u32 v254, s52, v2
    v_lshrrev_b32 v212, 4, v1
    v_xor_b32 v212, v212, v1
    v_and_b32 v212, 1, v212
    v_cmp_eq_u32 vcc, 0, v212
    v_mov_b32 v212, 0x3f803f80
    s_nop 0
    v_cndmask_b32 v240, 0, v212, vcc
    v_mov_b32 v241, v240
    v_mov_b64 v[242:243], v[240:241]
    v_and_b32 v208, 18, v1
    v_lshlrev_b32 v208, 1, v208
    v_and_or_b32 v208, v1, 8, v208
    v_and_b32 v209, 4, v1
    v_lshl_or_b32 v208, v209, 2, v208
    v_and_b32 v209, 33, v1
    v_lshl_or_b32 v252, v209, 25, v208
    v_lshl_or_b32 v252, v209, 30, v252
    v_mov_b32 v216, -1
    buffer_store_dword v216, v14, s[24:27], s85 offen sc1
    s_sub_u32 s85, s85, 262144
L_first:
    s_barrier
    ds_read_b128 v[128:131], v10 offset:0
    ds_read_b64_tr_b16 v[160:161], v12 offset:0
    ds_read_b64_tr_b16 v[162:163], v12 offset:512
    ds_read_b128 v[132:135], v10 offset:2048
    ds_read_b128 v[136:139], v10 offset:4096
    ds_read_b128 v[140:143], v10 offset:6144
    ds_read_b64_tr_b16 v[164:165], v13 offset:0
    ds_read_b64_tr_b16 v[166:167], v13 offset:512
    ds_read_b64_tr_b16 v[168:169], v12 offset:8192
    ds_read_b64_tr_b16 v[170:171], v12 offset:8704
    ds_read_b64_tr_b16 v[172:173], v13 offset:8192
    ds_read_b64_tr_b16 v[174:175], v13 offset:8704
    ds_read_b64_tr_b16 v[176:177], v12 offset:16384
    ds_read_b64_tr_b16 v[178:179], v12 offset:16896
    ds_read_b64_tr_b16 v[180:181], v13 offset:16384
    ds_read_b64_tr_b16 v[182:183], v13 offset:16896
    s_waitcnt lgkmcnt(13)
    v_mfma_f32_16x16x32_bf16 v[32:35], v[160:163], v[128:131], 0
    s_waitcnt lgkmcnt(12)
    v_mfma_f32_16x16x32_bf16 v[56:59], v[160:163], v[132:135], 0
    s_waitcnt lgkmcnt(11)
    v_mfma_f32_16x16x32_bf16 v[80:83], v[160:163], v[136:139], 0
    s_waitcnt lgkmcnt(10)
    v_mfma_f32_16x16x32_bf16 v[104:107], v[160:163], v[140:143], 0
    s_waitcnt lgkmcnt(8)
    v_mfma_f32_16x16x32_bf16 v[108:111], v[164:167], v[140:143], 0
    ds_read_b128 v[144:147], v11 offset:0
    v_mfma_f32_16x16x32_bf16 v[84:87], v[164:167], v[136:139], 0
    ds_read_b64_tr_b16 v[184:185], v12 offset:4096
    v_mfma_f32_16x16x32_bf16 v[60:63], v[164:167], v[132:135], 0
    ds_read_b64_tr_b16 v[186:187], v12 offset:4608
    v_mfma_f32_16x16x32_bf16 v[36:39], v[164:167], v[128:131], 0
    ds_read_b128 v[148:151], v11 offset:2048
    s_waitcnt lgkmcnt(10)
    v_mfma_f32_16x16x32_bf16 v[40:43], v[168:171], v[128:131], 0
    ds_read_b128 v[152:155], v11 offset:4096
    v_mfma_f32_16x16x32_bf16 v[64:67], v[168:171], v[132:135], 0
    ds_read_b128 v[156:159], v11 offset:6144
    v_mfma_f32_16x16x32_bf16 v[88:91], v[168:171], v[136:139], 0
    ds_read_b64_tr_b16 v[188:189], v13 offset:4096
    v_mfma_f32_16x16x32_bf16 v[112:115], v[168:171], v[140:143], 0
    ds_read_b64_tr_b16 v[190:191], v13 offset:4608
    s_waitcnt lgkmcnt(12)
    v_mfma_f32_16x16x32_bf16 v[116:119], v[172:175], v[140:143], 0
    ds_read_b64_tr_b16 v[192:193], v12 offset:12288
    v_mfma_f32_16x16x32_bf16 v[92:95], v[172:175], v[136:139], 0
    ds_read_b64_tr_b16 v[194:195], v12 offset:12800
    v_mfma_f32_16x16x32_bf16 v[68:71], v[172:175], v[132:135], 0
    ds_read_b64_tr_b16 v[196:197], v13 offset:12288
    v_mfma_f32_16x16x32_bf16 v[44:47], v[172:175], v[128:131], 0
    ds_read_b64_tr_b16 v[198:199], v13 offset:12800
    s_waitcnt lgkmcnt(14)
    v_mfma_f32_16x16x32_bf16 v[48:51], v[128:131], v[176:179], 0
    ds_read_b64_tr_b16 v[200:201], v12 offset:20480
    v_mfma_f32_16x16x32_bf16 v[72:75], v[132:135], v[176:179], 0
    ds_read_b64_tr_b16 v[202:203], v12 offset:20992
    v_mfma_f32_16x16x32_bf16 v[96:99], v[136:139], v[176:179], 0
    ds_read_b64_tr_b16 v[204:205], v13 offset:20480
    v_mfma_f32_16x16x32_bf16 v[120:123], v[140:143], v[176:179], 0
    ds_read_b64_tr_b16 v[206:207], v13 offset:20992
    s_waitcnt lgkmcnt(14)
    v_mfma_f32_16x16x32_bf16 v[124:127], v[140:143], v[180:183], 0
    v_mfma_f32_16x16x32_bf16 v[100:103], v[136:139], v[180:183], 0
    v_mfma_f32_16x16x32_bf16 v[76:79], v[132:135], v[180:183], 0
    v_mfma_f32_16x16x32_bf16 v[52:55], v[128:131], v[180:183], 0
    s_waitcnt vmcnt(0)
    s_cmp_lg_u32 s51, 0
    s_cbranch_scc0 L_skip_1
    s_mov_b64 exec, 1
    buffer_store_dword v0, off, s[24:27], s86
    buffer_store_dword v0, off, s[24:27], s87 sc1
    s_mov_b64 exec, -1
L_skip_1:
    s_waitcnt lgkmcnt(0)
    v_mfma_f32_16x16x32_bf16 v[32:35], v[184:187], v[144:147], v[32:35]
    v_add_u32 v208, 81920, v10
    v_add_u32 v209, 81920, v11
    v_mfma_f32_16x16x32_bf16 v[56:59], v[184:187], v[148:151], v[56:59]
    v_add_u32 v210, 81920, v12
    v_add_u32 v211, 81920, v13
    v_mfma_f32_16x16x32_bf16 v[80:83], v[184:187], v[152:155], v[80:83]
    s_mov_b32 s62, 0
    s_lshl_b32 s52, s51, 22
    v_mfma_f32_16x16x32_bf16 v[104:107], v[184:187], v[156:159], v[104:107]
    s_lshl_b32 s61, s48, 18
    s_add_u32 s52, s52, s61
    v_mfma_f32_16x16x32_bf16 v[108:111], v[188:191], v[156:159], v[108:111]
    s_add_u32 s52, s52, 0x1800000
    s_lshl_b32 s77, s50, 16
    v_mfma_f32_16x16x32_bf16 v[84:87], v[188:191], v[152:155], v[84:87]
    s_add_u32 s77, s77, s52
    s_lshl_b32 s78, s95, 11
    v_mfma_f32_16x16x32_bf16 v[60:63], v[188:191], v[148:151], v[60:63]
    s_add_u32 s75, s77, s78
    s_add_u32 s76, s75, 32768
    v_mfma_f32_16x16x32_bf16 v[36:39], v[188:191], v[144:147], v[36:39]
    s_lshl_b32 s79, s65, 17
    s_lshl_b32 s61, s49, 11
    v_mfma_f32_16x16x32_bf16 v[40:43], v[192:195], v[144:147], v[40:43]
    s_add_u32 s79, s79, s61
    s_lshl_b32 s61, s66, 10
    v_mfma_f32_16x16x32_bf16 v[64:67], v[192:195], v[148:151], v[64:67]
    s_add_u32 s79, s79, s61
    s_add_u32 s79, s79, s52
    v_mfma_f32_16x16x32_bf16 v[88:91], v[192:195], v[152:155], v[88:91]
    s_lshl_b32 s71, s49, 14
    s_lshl_b32 s61, s50, 12
    v_mfma_f32_16x16x32_bf16 v[112:115], v[192:195], v[156:159], v[112:115]
    s_add_u32 s71, s71, s61
    s_add_u32 s71, s71, s52
    v_mfma_f32_16x16x32_bf16 v[116:119], v[196:199], v[156:159], v[116:119]
    s_sub_u32 s71, s71, 0xc00000
    s_add_u32 s72, s71, 1024
    v_mfma_f32_16x16x32_bf16 v[92:95], v[196:199], v[152:155], v[92:95]
    s_add_u32 s73, s71, 2048
    s_add_u32 s74, s71, 3072
    v_mfma_f32_16x16x32_bf16 v[68:71], v[196:199], v[148:151], v[68:71]
    s_lshl_b32 s84, s51, 13
    s_lshl_b32 s61, s48, 8
    v_mfma_f32_16x16x32_bf16 v[44:47], v[196:199], v[144:147], v[44:47]
    s_add_u32 s84, s84, s61
    s_lshl_b32 s86, s49, 4
    v_mfma_f32_16x16x32_bf16 v[48:51], v[144:147], v[200:203], v[48:51]
    s_lshl_b32 s61, s50, 2
    s_add_u32 s86, s86, s61
    v_mfma_f32_16x16x32_bf16 v[72:75], v[148:151], v[200:203], v[72:75]
    s_add_u32 s86, s86, s84
    s_lshl_b32 s87, s86, 5
    v_mfma_f32_16x16x32_bf16 v[96:99], v[152:155], v[200:203], v[96:99]
    s_add_u32 s87, s87, 0x700000
    s_lshl_b32 s86, s86, 0
    v_mfma_f32_16x16x32_bf16 v[120:123], v[156:159], v[200:203], v[120:123]
    s_lshl_b32 s52, s65, 3
    s_lshl_b32 s61, s95, 4
    v_mfma_f32_16x16x32_bf16 v[124:127], v[156:159], v[204:207], v[124:127]
    s_add_u32 s52, s52, s61
    s_add_u32 s84, s84, s52
    v_mfma_f32_16x16x32_bf16 v[100:103], v[152:155], v[204:207], v[100:103]
    v_mfma_f32_16x16x32_bf16 v[76:79], v[148:151], v[204:207], v[76:79]
    v_mfma_f32_16x16x32_bf16 v[52:55], v[144:147], v[204:207], v[52:55]
    s_bitcmp1_b32 s51, 0
    s_cbranch_scc1 L_preB
    s_lshl_b32 s52, s51, 4
    s_lshl_b32 s61, s49, 1
    s_add_u32 s52, s52, s61
    s_add_u32 s52, s52, s66
    s_lshl_b32 s82, s52, 16
    s_lshl_b32 s61, s65, 15
    s_add_u32 s82, s82, s61
    s_lshl_b32 s61, s48, 11
    s_add_u32 s82, s82, s61
    s_add_u32 s82, s82, 0x800000
    s_lshl_b32 s83, s52, 11
    s_lshl_b32 s61, s48, 7
    s_add_u32 s83, s83, s61
    s_lshl_b32 s61, s65, 6
    s_add_u32 s83, s83, s61
    s_add_u32 s83, s83, 0x680000
    s_lshl_b32 s80, s52, 7
    s_add_u32 s80, s80, 0x6c0000
    s_lshl_b32 s81, s52, 12
    s_add_u32 s81, s81, 0x600000
    s_branch L_pre_done
L_preB:
    s_lshl_b32 s80, s51, 19
    s_lshl_b32 s61, s48, 16
    s_add_u32 s80, s80, s61
    s_lshl_b32 s61, s49, 12
    s_add_u32 s80, s80, s61
    s_lshl_b32 s61, s66, 11
    s_add_u32 s80, s80, s61
    s_add_u32 s80, s80, 0x380000
    s_add_u32 s81, s80, 65536
    s_cmp_eq_u32 s48, 15
    s_cselect_b32 s81, 1073741824, s81
    s_cmp_eq_u32 s65, 0
    s_cselect_b32 s81, 1073741824, s81
    s_cselect_b32 s80, s80, 1073741824
    s_cmp_eq_u32 s48, 0
    s_cselect_b32 s80, 1073741824, s80
    s_add_u32 s82, s79, 65536
    s_cmp_eq_u32 s51, 3
    s_cbranch_scc0 L_skip_2
    s_mov_b64 s[40:41], s[18:19]
    s_mov_b32 s42, 4194304
    s_lshl_b32 s71, s48, 18
    s_lshl_b32 s61, s50, 16
    s_add_u32 s71, s71, s61
    s_lshl_b32 s61, s49, 7
    s_add_u32 s71, s71, s61
    s_add_u32 s72, s71, 64
    s_add_u32 s73, s71, 32768
    s_add_u32 s74, s71, 32832
    v_mov_b32 v15, v3
L_skip_2:
L_pre_done:
    s_add_u32 s85, s85, 262144
    v_dot2_f32_bf16 v216, s70, v16, 0
    v_dot2_f32_bf16 v217, v16, v16, 0
    v_dot2_f32_bf16 v218, s70, v24, 0
    v_dot2_f32_bf16 v219, v24, v24, 0
    v_dot2_f32_bf16 v216, s70, v17, v216
    v_dot2_f32_bf16 v217, v17, v17, v217
    v_dot2_f32_bf16 v218, s70, v25, v218
    v_dot2_f32_bf16 v219, v25, v25, v219
    v_dot2_f32_bf16 v216, s70, v18, v216
    v_dot2_f32_bf16 v217, v18, v18, v217
    v_dot2_f32_bf16 v218, s70, v26, v218
    v_dot2_f32_bf16 v219, v26, v26, v219
    v_dot2_f32_bf16 v216, s70, v19, v216
    v_dot2_f32_bf16 v217, v19, v19, v217
    v_dot2_f32_bf16 v218, s70, v27, v218
    v_dot2_f32_bf16 v219, v27, v27, v219
    v_dot2_f32_bf16 v216, s70, v20, v216
    v_dot2_f32_bf16 v217, v20, v20, v217
    v_dot2_f32_bf16 v218, s70, v28, v218
    v_dot2_f32_bf16 v219, v28, v28, v219
    v_dot2_f32_bf16 v216, s70, v21, v216
    v_dot2_f32_bf16 v217, v21, v21, v217
    v_dot2_f32_bf16 v218, s70, v29, v218
    v_dot2_f32_bf16 v219, v29, v29, v219
    v_dot2_f32_bf16 v216, s70, v22, v216
    v_dot2_f32_bf16 v217, v22, v22, v217
    v_dot2_f32_bf16 v218, s70, v30, v218
    v_dot2_f32_bf16 v219, v30, v30, v219
    v_dot2_f32_bf16 v216, s70, v23, v216
    v_dot2_f32_bf16 v217, v23, v23, v217
    v_dot2_f32_bf16 v218, s70, v31, v218
    v_dot2_f32_bf16 v219, v31, v31, v219
    s_nop 1
    v_permlane32_swap_b32 v216, v218
    v_permlane32_swap_b32 v217, v219
    v_pk_add_f32 v[216:217], v[216:217], v[218:219]
    s_nop 1
    v_permlane16_swap_b32 v216, v217
    v_add_f32 v216, v216, v217
    buffer_store_dword v216, v14, s[24:27], s85 offen sc1
L_go:
    s_barrier
    ds_read_b128 v[128:131], v10 offset:40960
    ds_read_b64_tr_b16 v[160:161], v12 offset:40960
    ds_read_b64_tr_b16 v[162:163], v12 offset:41472
    ds_read_b128 v[132:135], v10 offset:43008
    ds_read_b128 v[136:139], v10 offset:45056
    ds_read_b128 v[140:143], v10 offset:47104
    ds_read_b64_tr_b16 v[164:165], v13 offset:40960
    ds_read_b64_tr_b16 v[166:167], v13 offset:41472
    ds_read_b64_tr_b16 v[168:169], v12 offset:49152
    ds_read_b64_tr_b16 v[170:171], v12 offset:49664
    ds_read_b64_tr_b16 v[172:173], v13 offset:49152
    ds_read_b64_tr_b16 v[174:175], v13 offset:49664
    ds_read_b64_tr_b16 v[176:177], v12 offset:57344
    ds_read_b64_tr_b16 v[178:179], v12 offset:57856
    ds_read_b64_tr_b16 v[180:181], v13 offset:57344
    ds_read_b64_tr_b16 v[182:183], v13 offset:57856
    s_branch L_q1
.p2align 6
L_q:
    ds_read_b128 v[128:131], v10 offset:40960
    v_mfma_f32_16x16x32_bf16 v[80:83], v[184:187], v[152:155], v[80:83]
    ds_read_b64_tr_b16 v[160:161], v12 offset:40960
    v_mfma_f32_16x16x32_bf16 v[104:107], v[184:187], v[156:159], v[104:107]
    ds_read_b64_tr_b16 v[162:163], v12 offset:41472
    v_mfma_f32_16x16x32_bf16 v[108:111], v[188:191], v[156:159], v[108:111]
    ds_read_b128 v[132:135], v10 offset:43008
    v_mfma_f32_16x16x32_bf16 v[84:87], v[188:191], v[152:155], v[84:87]
    ds_read_b128 v[136:139], v10 offset:45056
    v_mfma_f32_16x16x32_bf16 v[60:63], v[188:191], v[148:151], v[60:63]
    ds_read_b128 v[140:143], v10 offset:47104
    v_mfma_f32_16x16x32_bf16 v[36:39], v[188:191], v[144:147], v[36:39]
    ds_read_b64_tr_b16 v[164:165], v13 offset:40960
    v_mfma_f32_16x16x32_bf16 v[40:43], v[192:195], v[144:147], v[40:43]
    ds_read_b64_tr_b16 v[166:167], v13 offset:41472
    v_mfma_f32_16x16x32_bf16 v[64:67], v[192:195], v[148:151], v[64:67]
    ds_read_b64_tr_b16 v[168:169], v12 offset:49152
    v_mfma_f32_16x16x32_bf16 v[88:91], v[192:195], v[152:155], v[88:91]
    ds_read_b64_tr_b16 v[170:171], v12 offset:49664
    v_mfma_f32_16x16x32_bf16 v[112:115], v[192:195], v[156:159], v[112:115]
    ds_read_b64_tr_b16 v[172:173], v13 offset:49152
    v_mfma_f32_16x16x32_bf16 v[116:119], v[196:199], v[156:159], v[116:119]
    ds_read_b64_tr_b16 v[174:175], v13 offset:49664
    v_mfma_f32_16x16x32_bf16 v[92:95], v[196:199], v[152:155], v[92:95]
    ds_read_b64_tr_b16 v[176:177], v12 offset:57344
    v_mfma_f32_16x16x32_bf16 v[68:71], v[196:199], v[148:151], v[68:71]
    ds_read_b64_tr_b16 v[178:179], v12 offset:57856
    v_mfma_f32_16x16x32_bf16 v[44:47], v[196:199], v[144:147], v[44:47]
    ds_read_b64_tr_b16 v[180:181], v13 offset:57344
    v_mfma_f32_16x16x32_bf16 v[48:51], v[144:147], v[200:203], v[48:51]
    ds_read_b64_tr_b16 v[182:183], v13 offset:57856
    v_mfma_f32_16x16x32_bf16 v[72:75], v[148:151], v[200:203], v[72:75]
    v_mfma_f32_16x16x32_bf16 v[96:99], v[152:155], v[200:203], v[96:99]
    v_mfma_f32_16x16x32_bf16 v[120:123], v[156:159], v[200:203], v[120:123]
    v_mfma_f32_16x16x32_bf16 v[124:127], v[156:159], v[204:207], v[124:127]
    v_mfma_f32_16x16x32_bf16 v[100:103], v[152:155], v[204:207], v[100:103]
    v_mfma_f32_16x16x32_bf16 v[76:79], v[148:151], v[204:207], v[76:79]
    v_mfma_f32_16x16x32_bf16 v[52:55], v[144:147], v[204:207], v[52:55]
L_q1:
    s_waitcnt lgkmcnt(0)
    v_mfma_f32_16x16x32_bf16 v[32:35], v[160:163], v[128:131], v[32:35]
    v_mfma_f32_16x16x32_bf16 v[56:59], v[160:163], v[132:135], v[56:59]
    v_mfma_f32_16x16x32_bf16 v[80:83], v[160:163], v[136:139], v[80:83]
    ds_read_b128 v[144:147], v11 offset:40960
    v_mfma_f32_16x16x32_bf16 v[104:107], v[160:163], v[140:143], v[104:107]
    ds_read_b64_tr_b16 v[184:185], v12 offset:45056
    v_mfma_f32_16x16x32_bf16 v[108:111], v[164:167], v[140:143], v[108:111]
    ds_read_b64_tr_b16 v[186:187], v12 offset:45568
    v_mfma_f32_16x16x32_bf16 v[84:87], v[164:167], v[136:139], v[84:87]
    ds_read_b128 v[148:151], v11 offset:43008
    v_mfma_f32_16x16x32_bf16 v[60:63], v[164:167], v[132:135], v[60:63]
    ds_read_b128 v[152:155], v11 offset:45056
    v_mfma_f32_16x16x32_bf16 v[36:39], v[164:167], v[128:131], v[36:39]
    ds_read_b128 v[156:159], v11 offset:47104
    v_mfma_f32_16x16x32_bf16 v[40:43], v[168:171], v[128:131], v[40:43]
    ds_read_b64_tr_b16 v[188:189], v13 offset:45056
    v_mfma_f32_16x16x32_bf16 v[64:67], v[168:171], v[132:135], v[64:67]
    ds_read_b64_tr_b16 v[190:191], v13 offset:45568
    v_mfma_f32_16x16x32_bf16 v[88:91], v[168:171], v[136:139], v[88:91]
    ds_read_b64_tr_b16 v[192:193], v12 offset:53248
    v_mfma_f32_16x16x32_bf16 v[112:115], v[168:171], v[140:143], v[112:115]
    ds_read_b64_tr_b16 v[194:195], v12 offset:53760
    v_mfma_f32_16x16x32_bf16 v[116:119], v[172:175], v[140:143], v[116:119]
    ds_read_b64_tr_b16 v[196:197], v13 offset:53248
    v_mfma_f32_16x16x32_bf16 v[92:95], v[172:175], v[136:139], v[92:95]
    ds_read_b64_tr_b16 v[198:199], v13 offset:53760
    v_mfma_f32_16x16x32_bf16 v[68:71], v[172:175], v[132:135], v[68:71]
    ds_read_b64_tr_b16 v[200:201], v12 offset:61440
    v_mfma_f32_16x16x32_bf16 v[44:47], v[172:175], v[128:131], v[44:47]
    ds_read_b64_tr_b16 v[202:203], v12 offset:61952
    v_mfma_f32_16x16x32_bf16 v[48:51], v[128:131], v[176:179], v[48:51]
    ds_read_b64_tr_b16 v[204:205], v13 offset:61440
    v_mfma_f32_16x16x32_bf16 v[72:75], v[132:135], v[176:179], v[72:75]
    ds_read_b64_tr_b16 v[206:207], v13 offset:61952
    v_mfma_f32_16x16x32_bf16 v[96:99], v[136:139], v[176:179], v[96:99]
    v_mfma_f32_16x16x32_bf16 v[120:123], v[140:143], v[176:179], v[120:123]
    v_mfma_f32_16x16x32_bf16 v[124:127], v[140:143], v[180:183], v[124:127]
    v_mfma_f32_16x16x32_bf16 v[100:103], v[136:139], v[180:183], v[100:103]
    v_mfma_f32_16x16x32_bf16 v[76:79], v[132:135], v[180:183], v[76:79]
    v_mfma_f32_16x16x32_bf16 v[52:55], v[128:131], v[180:183], v[52:55]
    s_waitcnt lgkmcnt(0)
    v_mfma_f32_16x16x32_bf16 v[32:35], v[184:187], v[144:147], v[32:35]
    v_mfma_f32_16x16x32_bf16 v[56:59], v[184:187], v[148:151], v[56:59]
    s_barrier
    ds_read_b128 v[128:131], v208 offset:0
    v_mfma_f32_16x16x32_bf16 v[80:83], v[184:187], v[152:155], v[80:83]
    ds_read_b64_tr_b16 v[160:161], v210 offset:0
    v_mfma_f32_16x16x32_bf16 v[104:107], v[184:187], v[156:159], v[104:107]
    ds_read_b64_tr_b16 v[162:163], v210 offset:512
    v_mfma_f32_16x16x32_bf16 v[108:111], v[188:191], v[156:159], v[108:111]
    ds_read_b128 v[132:135], v208 offset:2048
    v_mfma_f32_16x16x32_bf16 v[84:87], v[188:191], v[152:155], v[84:87]
    ds_read_b128 v[136:139], v208 offset:4096
    v_mfma_f32_16x16x32_bf16 v[60:63], v[188:191], v[148:151], v[60:63]
    ds_read_b128 v[140:143], v208 offset:6144
    v_mfma_f32_16x16x32_bf16 v[36:39], v[188:191], v[144:147], v[36:39]
    ds_read_b64_tr_b16 v[164:165], v211 offset:0
    v_mfma_f32_16x16x32_bf16 v[40:43], v[192:195], v[144:147], v[40:43]
    ds_read_b64_tr_b16 v[166:167], v211 offset:512
    v_mfma_f32_16x16x32_bf16 v[64:67], v[192:195], v[148:151], v[64:67]
    ds_read_b64_tr_b16 v[168:169], v210 offset:8192
    v_mfma_f32_16x16x32_bf16 v[88:91], v[192:195], v[152:155], v[88:91]
    ds_read_b64_tr_b16 v[170:171], v210 offset:8704
    v_mfma_f32_16x16x32_bf16 v[112:115], v[192:195], v[156:159], v[112:115]
    ds_read_b64_tr_b16 v[172:173], v211 offset:8192
    v_mfma_f32_16x16x32_bf16 v[116:119], v[196:199], v[156:159], v[116:119]
    ds_read_b64_tr_b16 v[174:175], v211 offset:8704
    v_mfma_f32_16x16x32_bf16 v[92:95], v[196:199], v[152:155], v[92:95]
    ds_read_b64_tr_b16 v[176:177], v210 offset:16384
    v_mfma_f32_16x16x32_bf16 v[68:71], v[196:199], v[148:151], v[68:71]
    ds_read_b64_tr_b16 v[178:179], v210 offset:16896
    v_mfma_f32_16x16x32_bf16 v[44:47], v[196:199], v[144:147], v[44:47]
    ds_read_b64_tr_b16 v[180:181], v211 offset:16384
    v_mfma_f32_16x16x32_bf16 v[48:51], v[144:147], v[200:203], v[48:51]
    ds_read_b64_tr_b16 v[182:183], v211 offset:16896
    v_mfma_f32_16x16x32_bf16 v[72:75], v[148:151], v[200:203], v[72:75]
    v_mfma_f32_16x16x32_bf16 v[96:99], v[152:155], v[200:203], v[96:99]
    v_mfma_f32_16x16x32_bf16 v[120:123], v[156:159], v[200:203], v[120:123]
    v_mfma_f32_16x16x32_bf16 v[124:127], v[156:159], v[204:207], v[124:127]
    v_mfma_f32_16x16x32_bf16 v[100:103], v[152:155], v[204:207], v[100:103]
    v_mfma_f32_16x16x32_bf16 v[76:79], v[148:151], v[204:207], v[76:79]
    v_mfma_f32_16x16x32_bf16 v[52:55], v[144:147], v[204:207], v[52:55]
    s_waitcnt lgkmcnt(0)
    v_mfma_f32_16x16x32_bf16 v[32:35], v[160:163], v[128:131], v[32:35]
    v_mfma_f32_16x16x32_bf16 v[56:59], v[160:163], v[132:135], v[56:59]
    v_mfma_f32_16x16x32_bf16 v[80:83], v[160:163], v[136:139], v[80:83]
    ds_read_b128 v[144:147], v209 offset:0
    v_mfma_f32_16x16x32_bf16 v[104:107], v[160:163], v[140:143], v[104:107]
    ds_read_b64_tr_b16 v[184:185], v210 offset:4096
    v_mfma_f32_16x16x32_bf16 v[108:111], v[164:167], v[140:143], v[108:111]
    ds_read_b64_tr_b16 v[186:187], v210 offset:4608
    v_mfma_f32_16x16x32_bf16 v[84:87], v[164:167], v[136:139], v[84:87]
    ds_read_b128 v[148:151], v209 offset:2048
    v_mfma_f32_16x16x32_bf16 v[60:63], v[164:167], v[132:135], v[60:63]
    ds_read_b128 v[152:155], v209 offset:4096
    v_mfma_f32_16x16x32_bf16 v[36:39], v[164:167], v[128:131], v[36:39]
    ds_read_b128 v[156:159], v209 offset:6144
    v_mfma_f32_16x16x32_bf16 v[40:43], v[168:171], v[128:131], v[40:43]
    ds_read_b64_tr_b16 v[188:189], v211 offset:4096
    v_mfma_f32_16x16x32_bf16 v[64:67], v[168:171], v[132:135], v[64:67]
    ds_read_b64_tr_b16 v[190:191], v211 offset:4608
    v_mfma_f32_16x16x32_bf16 v[88:91], v[168:171], v[136:139], v[88:91]
    ds_read_b64_tr_b16 v[192:193], v210 offset:12288
    v_mfma_f32_16x16x32_bf16 v[112:115], v[168:171], v[140:143], v[112:115]
    ds_read_b64_tr_b16 v[194:195], v210 offset:12800
    v_mfma_f32_16x16x32_bf16 v[116:119], v[172:175], v[140:143], v[116:119]
    ds_read_b64_tr_b16 v[196:197], v211 offset:12288
    v_mfma_f32_16x16x32_bf16 v[92:95], v[172:175], v[136:139], v[92:95]
    ds_read_b64_tr_b16 v[198:199], v211 offset:12800
    v_mfma_f32_16x16x32_bf16 v[68:71], v[172:175], v[132:135], v[68:71]
    ds_read_b64_tr_b16 v[200:201], v210 offset:20480
    v_mfma_f32_16x16x32_bf16 v[44:47], v[172:175], v[128:131], v[44:47]
    ds_read_b64_tr_b16 v[202:203], v210 offset:20992
    v_mfma_f32_16x16x32_bf16 v[48:51], v[128:131], v[176:179], v[48:51]
    ds_read_b64_tr_b16 v[204:205], v211 offset:20480
    v_mfma_f32_16x16x32_bf16 v[72:75], v[132:135], v[176:179], v[72:75]
    ds_read_b64_tr_b16 v[206:207], v211 offset:20992
    v_mfma_f32_16x16x32_bf16 v[96:99], v[136:139], v[176:179], v[96:99]
    v_mfma_f32_16x16x32_bf16 v[120:123], v[140:143], v[176:179], v[120:123]
    v_mfma_f32_16x16x32_bf16 v[124:127], v[140:143], v[180:183], v[124:127]
    v_mfma_f32_16x16x32_bf16 v[100:103], v[136:139], v[180:183], v[100:103]
    v_mfma_f32_16x16x32_bf16 v[76:79], v[132:135], v[180:183], v[76:79]
    v_mfma_f32_16x16x32_bf16 v[52:55], v[128:131], v[180:183], v[52:55]
    s_waitcnt lgkmcnt(0)
    v_mfma_f32_16x16x32_bf16 v[32:35], v[184:187], v[144:147], v[32:35]
    v_mfma_f32_16x16x32_bf16 v[56:59], v[184:187], v[148:151], v[56:59]
    s_barrier
    ds_read_b128 v[128:131], v10 offset:0
    v_mfma_f32_16x16x32_bf16 v[80:83], v[184:187], v[152:155], v[80:83]
    ds_read_b64_tr_b16 v[160:161], v12 offset:0
    v_mfma_f32_16x16x32_bf16 v[104:107], v[184:187], v[156:159], v[104:107]
    ds_read_b64_tr_b16 v[162:163], v12 offset:512
    v_mfma_f32_16x16x32_bf16 v[108:111], v[188:191], v[156:159], v[108:111]
    ds_read_b128 v[132:135], v10 offset:2048
    v_mfma_f32_16x16x32_bf16 v[84:87], v[188:191], v[152:155], v[84:87]
    ds_read_b128 v[136:139], v10 offset:4096
    v_mfma_f32_16x16x32_bf16 v[60:63], v[188:191], v[148:151], v[60:63]
    ds_read_b128 v[140:143], v10 offset:6144
    v_mfma_f32_16x16x32_bf16 v[36:39], v[188:191], v[144:147], v[36:39]
    ds_read_b64_tr_b16 v[164:165], v13 offset:0
    v_mfma_f32_16x16x32_bf16 v[40:43], v[192:195], v[144:147], v[40:43]
    ds_read_b64_tr_b16 v[166:167], v13 offset:512
    v_mfma_f32_16x16x32_bf16 v[64:67], v[192:195], v[148:151], v[64:67]
    ds_read_b64_tr_b16 v[168:169], v12 offset:8192
    v_mfma_f32_16x16x32_bf16 v[88:91], v[192:195], v[152:155], v[88:91]
    ds_read_b64_tr_b16 v[170:171], v12 offset:8704
    v_mfma_f32_16x16x32_bf16 v[112:115], v[192:195], v[156:159], v[112:115]
    ds_read_b64_tr_b16 v[172:173], v13 offset:8192
    v_mfma_f32_16x16x32_bf16 v[116:119], v[196:199], v[156:159], v[116:119]
    ds_read_b64_tr_b16 v[174:175], v13 offset:8704
    v_mfma_f32_16x16x32_bf16 v[92:95], v[196:199], v[152:155], v[92:95]
    ds_read_b64_tr_b16 v[176:177], v12 offset:16384
    v_mfma_f32_16x16x32_bf16 v[68:71], v[196:199], v[148:151], v[68:71]
    ds_read_b64_tr_b16 v[178:179], v12 offset:16896
    v_mfma_f32_16x16x32_bf16 v[44:47], v[196:199], v[144:147], v[44:47]
    ds_read_b64_tr_b16 v[180:181], v13 offset:16384
    v_mfma_f32_16x16x32_bf16 v[48:51], v[144:147], v[200:203], v[48:51]
    ds_read_b64_tr_b16 v[182:183], v13 offset:16896
    v_mfma_f32_16x16x32_bf16 v[72:75], v[148:151], v[200:203], v[72:75]
    v_mfma_f32_16x16x32_bf16 v[96:99], v[152:155], v[200:203], v[96:99]
    v_mfma_f32_16x16x32_bf16 v[120:123], v[156:159], v[200:203], v[120:123]
    v_mfma_f32_16x16x32_bf16 v[124:127], v[156:159], v[204:207], v[124:127]
    v_mfma_f32_16x16x32_bf16 v[100:103], v[152:155], v[204:207], v[100:103]
    v_mfma_f32_16x16x32_bf16 v[76:79], v[148:151], v[204:207], v[76:79]
    v_mfma_f32_16x16x32_bf16 v[52:55], v[144:147], v[204:207], v[52:55]
    s_waitcnt lgkmcnt(0)
    v_mfma_f32_16x16x32_bf16 v[32:35], v[160:163], v[128:131], v[32:35]
    v_mfma_f32_16x16x32_bf16 v[56:59], v[160:163], v[132:135], v[56:59]
    v_mfma_f32_16x16x32_bf16 v[80:83], v[160:163], v[136:139], v[80:83]
    ds_read_b128 v[144:147], v11 offset:0
    v_mfma_f32_16x16x32_bf16 v[104:107], v[160:163], v[140:143], v[104:107]
    ds_read_b64_tr_b16 v[184:185], v12 offset:4096
    v_mfma_f32_16x16x32_bf16 v[108:111], v[164:167], v[140:143], v[108:111]
    ds_read_b64_tr_b16 v[186:187], v12 offset:4608
    v_mfma_f32_16x16x32_bf16 v[84:87], v[164:167], v[136:139], v[84:87]
    ds_read_b128 v[148:151], v11 offset:2048
    v_mfma_f32_16x16x32_bf16 v[60:63], v[164:167], v[132:135], v[60:63]
    ds_read_b128 v[152:155], v11 offset:4096
    v_mfma_f32_16x16x32_bf16 v[36:39], v[164:167], v[128:131], v[36:39]
    ds_read_b128 v[156:159], v11 offset:6144
    v_mfma_f32_16x16x32_bf16 v[40:43], v[168:171], v[128:131], v[40:43]
    ds_read_b64_tr_b16 v[188:189], v13 offset:4096
    v_mfma_f32_16x16x32_bf16 v[64:67], v[168:171], v[132:135], v[64:67]
    ds_read_b64_tr_b16 v[190:191], v13 offset:4608
    v_mfma_f32_16x16x32_bf16 v[88:91], v[168:171], v[136:139], v[88:91]
    ds_read_b64_tr_b16 v[192:193], v12 offset:12288
    v_mfma_f32_16x16x32_bf16 v[112:115], v[168:171], v[140:143], v[112:115]
    ds_read_b64_tr_b16 v[194:195], v12 offset:12800
    v_mfma_f32_16x16x32_bf16 v[116:119], v[172:175], v[140:143], v[116:119]
    ds_read_b64_tr_b16 v[196:197], v13 offset:12288
    v_mfma_f32_16x16x32_bf16 v[92:95], v[172:175], v[136:139], v[92:95]
    ds_read_b64_tr_b16 v[198:199], v13 offset:12800
    v_mfma_f32_16x16x32_bf16 v[68:71], v[172:175], v[132:135], v[68:71]
    ds_read_b64_tr_b16 v[200:201], v12 offset:20480
    v_mfma_f32_16x16x32_bf16 v[44:47], v[172:175], v[128:131], v[44:47]
    ds_read_b64_tr_b16 v[202:203], v12 offset:20992
    v_mfma_f32_16x16x32_bf16 v[48:51], v[128:131], v[176:179], v[48:51]
    ds_read_b64_tr_b16 v[204:205], v13 offset:20480
    v_mfma_f32_16x16x32_bf16 v[72:75], v[132:135], v[176:179], v[72:75]
    ds_read_b64_tr_b16 v[206:207], v13 offset:20992
    v_mfma_f32_16x16x32_bf16 v[96:99], v[136:139], v[176:179], v[96:99]
    s_add_u32 s62, s62, 3
    v_mfma_f32_16x16x32_bf16 v[120:123], v[140:143], v[176:179], v[120:123]
    s_cmp_lt_u32 s62, 15
    v_mfma_f32_16x16x32_bf16 v[124:127], v[140:143], v[180:183], v[124:127]
    v_mfma_f32_16x16x32_bf16 v[100:103], v[136:139], v[180:183], v[100:103]
    v_mfma_f32_16x16x32_bf16 v[76:79], v[132:135], v[180:183], v[76:79]
    v_mfma_f32_16x16x32_bf16 v[52:55], v[128:131], v[180:183], v[52:55]
    s_waitcnt lgkmcnt(0)
    v_mfma_f32_16x16x32_bf16 v[32:35], v[184:187], v[144:147], v[32:35]
    v_mfma_f32_16x16x32_bf16 v[56:59], v[184:187], v[148:151], v[56:59]
    s_barrier
    s_cbranch_scc1 L_q
L_tail:
    s_bitcmp1_b32 s51, 0
    s_cbranch_scc1 L_epiB
    v_mfma_f32_16x16x32_bf16 v[40:43], v[192:195], v[144:147], v[40:43]
    ds_read_b32 v232, v5 offset:0
    ds_read_b32 v233, v5 offset:64
    v_mfma_f32_16x16x32_bf16 v[44:47], v[196:199], v[144:147], v[44:47]
    ds_read_b32 v234, v5 offset:128
    ds_read_b32 v235, v5 offset:192
    v_mfma_f32_16x16x32_bf16 v[64:67], v[192:195], v[148:151], v[64:67]
    ds_read_b128 v[160:163], v8 offset:256
    ds_read_b128 v[164:167], v8 offset:320
    v_mfma_f32_16x16x32_bf16 v[68:71], v[196:199], v[148:151], v[68:71]
    ds_read_b64_tr_b16 v[224:225], v248 offset:0
    ds_read_b64_tr_b16 v[226:227], v248 offset:1024
    v_mfma_f32_16x16x32_bf16 v[88:91], v[192:195], v[152:155], v[88:91]
    ds_read_b64_tr_b16 v[228:229], v248 offset:256
    ds_read_b64_tr_b16 v[230:231], v248 offset:1280
    v_mfma_f32_16x16x32_bf16 v[92:95], v[196:199], v[152:155], v[92:95]
    ds_read_b32 v238, v9 offset:512
    ds_read_b32 v239, v9 offset:576
    v_mfma_f32_16x16x32_bf16 v[112:115], v[192:195], v[156:159], v[112:115]
    ds_read_b128 v[176:179], v6 offset:0
    ds_read_b128 v[180:183], v6 offset:512
    v_mfma_f32_16x16x32_bf16 v[116:119], v[196:199], v[156:159], v[116:119]
    ds_read_b32 v236, v7 offset:512
    ds_read_b32 v237, v7 offset:640
    v_mfma_f32_16x16x32_bf16 v[48:51], v[144:147], v[200:203], v[48:51]
    ds_read_b128 v[168:171], v6 offset:64
    ds_read_b128 v[172:175], v6 offset:576
    v_mfma_f32_16x16x32_bf16 v[52:55], v[144:147], v[204:207], v[52:55]
    ds_read_b128 v[208:211], v6 offset:128
    ds_read_b128 v[212:215], v6 offset:640
    v_mfma_f32_16x16x32_bf16 v[72:75], v[148:151], v[200:203], v[72:75]
    ds_read_b128 v[216:219], v6 offset:192
    ds_read_b128 v[220:223], v6 offset:704
    v_mfma_f32_16x16x32_bf16 v[76:79], v[148:151], v[204:207], v[76:79]
    s_waitcnt lgkmcnt(14)
    v_fmac_f32 v40, v160, v232
    v_fmac_f32 v41, v161, v232
    v_mfma_f32_16x16x32_bf16 v[96:99], v[152:155], v[200:203], v[96:99]
    v_fmac_f32 v42, v162, v232
    v_fmac_f32 v43, v163, v232
    v_mfma_f32_16x16x32_bf16 v[100:103], v[152:155], v[204:207], v[100:103]
    v_fmac_f32 v44, v164, v232
    v_fmac_f32 v45, v165, v232
    v_mfma_f32_16x16x32_bf16 v[120:123], v[156:159], v[200:203], v[120:123]
    v_fmac_f32 v46, v166, v232
    v_fmac_f32 v47, v167, v232
    v_mfma_f32_16x16x32_bf16 v[124:127], v[156:159], v[204:207], v[124:127]
    v_cvt_pk_bf16_f32 v40, v40, v41
    v_cvt_pk_bf16_f32 v41, v42, v43
    v_mfma_f32_16x16x32_bf16 v[36:39], v[188:191], v[144:147], v[36:39]
    v_cvt_pk_bf16_f32 v42, v44, v45
    v_cvt_pk_bf16_f32 v43, v46, v47
    v_mfma_f32_16x16x32_bf16 v[60:63], v[188:191], v[148:151], v[60:63]
    v_fmac_f32 v64, v160, v233
    v_fmac_f32 v65, v161, v233
    v_mfma_f32_16x16x32_bf16 v[84:87], v[188:191], v[152:155], v[84:87]
    v_fmac_f32 v66, v162, v233
    v_fmac_f32 v67, v163, v233
    v_mfma_f32_16x16x32_bf16 v[108:111], v[188:191], v[156:159], v[108:111]
    v_fmac_f32 v68, v164, v233
    v_fmac_f32 v69, v165, v233
    v_mfma_f32_16x16x32_bf16 v[80:83], v[184:187], v[152:155], v[80:83]
    v_fmac_f32 v70, v166, v233
    v_fmac_f32 v71, v167, v233
    v_mfma_f32_16x16x32_bf16 v[104:107], v[184:187], v[156:159], v[104:107]
    v_cvt_pk_bf16_f32 v64, v64, v65
    v_cvt_pk_bf16_f32 v65, v66, v67
    v_cvt_pk_bf16_f32 v66, v68, v69
    v_cvt_pk_bf16_f32 v67, v70, v71
    v_pk_fma_f32 v[88:89], v[160:161], v[234:235], v[88:89] op_sel_hi:[1,0,1]
    v_pk_fma_f32 v[112:113], v[160:161], v[234:235], v[112:113] op_sel:[0,1,0]
    v_pk_fma_f32 v[90:91], v[162:163], v[234:235], v[90:91] op_sel_hi:[1,0,1]
    v_pk_fma_f32 v[114:115], v[162:163], v[234:235], v[114:115] op_sel:[0,1,0]
    v_pk_fma_f32 v[92:93], v[164:165], v[234:235], v[92:93] op_sel_hi:[1,0,1]
    v_pk_fma_f32 v[94:95], v[166:167], v[234:235], v[94:95] op_sel_hi:[1,0,1]
    v_pk_fma_f32 v[116:117], v[164:165], v[234:235], v[116:117] op_sel:[0,1,0]
    v_pk_fma_f32 v[118:119], v[166:167], v[234:235], v[118:119] op_sel:[0,1,0]
    v_cvt_pk_bf16_f32 v88, v88, v89
    v_cvt_pk_bf16_f32 v112, v112, v113
    v_cvt_pk_bf16_f32 v89, v90, v91
    v_cvt_pk_bf16_f32 v113, v114, v115
    v_cvt_pk_bf16_f32 v90, v92, v93
    v_cvt_pk_bf16_f32 v91, v94, v95
    v_cvt_pk_bf16_f32 v114, v116, v117
    v_cvt_pk_bf16_f32 v115, v118, v119
    s_waitcnt lgkmcnt(9)
    v_pk_fma_f32 v[48:49], v[176:177], v[238:239], v[48:49] op_sel_hi:[1,0,1]
    v_pk_fma_f32 v[50:51], v[178:179], v[238:239], v[50:51] op_sel_hi:[1,0,1]
    v_pk_fma_f32 v[52:53], v[176:177], v[238:239], v[52:53] op_sel:[0,1,0]
    v_pk_fma_f32 v[54:55], v[178:179], v[238:239], v[54:55] op_sel:[0,1,0]
    s_waitcnt lgkmcnt(5)
    v_pk_fma_f32 v[72:73], v[168:169], v[238:239], v[72:73] op_sel_hi:[1,0,1]
    v_pk_fma_f32 v[74:75], v[170:171], v[238:239], v[74:75] op_sel_hi:[1,0,1]
    v_pk_fma_f32 v[76:77], v[168:169], v[238:239], v[76:77] op_sel:[0,1,0]
    v_pk_fma_f32 v[78:79], v[170:171], v[238:239], v[78:79] op_sel:[0,1,0]
    v_permlane16_swap_b32 v40, v64
    v_permlane16_swap_b32 v41, v65
    v_permlane16_swap_b32 v42, v66
    v_permlane16_swap_b32 v43, v67
    v_permlane16_swap_b32 v88, v112
    v_permlane16_swap_b32 v89, v113
    v_permlane16_swap_b32 v90, v114
    v_permlane16_swap_b32 v91, v115
    v_mul_f32 v236, 0x3fb8aa3b, v236
    v_mul_f32 v237, 0x3fb8aa3b, v237
    v_pk_mul_f32 v[48:49], v[48:49], v[180:181]
    v_pk_mul_f32 v[50:51], v[50:51], v[182:183]
    v_pk_mul_f32 v[52:53], v[52:53], v[180:181]
    v_pk_mul_f32 v[54:55], v[54:55], v[182:183]
    s_waitcnt lgkmcnt(4)
    v_pk_mul_f32 v[72:73], v[72:73], v[172:173]
    v_pk_mul_f32 v[74:75], v[74:75], v[174:175]
    v_pk_mul_f32 v[76:77], v[76:77], v[172:173]
    v_pk_mul_f32 v[78:79], v[78:79], v[174:175]
    v_mfma_f32_32x32x16_bf16 v[128:143], v[224:227], v[40:43], 0
    v_cvt_pk_bf16_f32 v48, v48, v49
    v_cvt_pk_bf16_f32 v72, v72, v73
    v_cvt_pk_bf16_f32 v49, v50, v51
    v_cvt_pk_bf16_f32 v73, v74, v75
    v_cvt_pk_bf16_f32 v50, v52, v53
    v_mfma_f32_32x32x16_bf16 v[128:143], v[228:231], v[64:67], v[128:143]
    v_cvt_pk_bf16_f32 v51, v54, v55
    v_cvt_pk_bf16_f32 v74, v76, v77
    v_cvt_pk_bf16_f32 v75, v78, v79
    v_permlane16_swap_b32 v48, v50
    v_permlane16_swap_b32 v49, v51
    v_mfma_f32_32x32x16_bf16 v[144:159], v[224:227], v[88:91], 0
    v_permlane16_swap_b32 v72, v74
    v_permlane16_swap_b32 v73, v75
    s_nop 3
    v_max3_f32 v93, -v128, -v129, -v130
    v_max3_f32 v92, v128, v129, v130
    v_max3_f32 v93, v93, -v131, -v132
    v_max3_f32 v92, v92, v131, v132
    v_max3_f32 v93, v93, -v133, -v134
    v_max3_f32 v92, v92, v133, v134
    v_max3_f32 v93, v93, -v135, -v136
    v_max3_f32 v92, v92, v135, v136
    v_max3_f32 v93, v93, -v137, -v138
    v_max3_f32 v92, v92, v137, v138
    v_max3_f32 v93, v93, -v139, -v140
    v_max3_f32 v92, v92, v139, v140
    v_max3_f32 v93, v93, -v141, -v142
    v_max3_f32 v92, v92, v141, v142
    v_max_f32 v93, v93, -v143
    v_max_f32 v92, v92, v143
    v_mfma_f32_32x32x16_bf16 v[144:159], v[228:231], v[112:115], v[144:159]
    s_nop 0
    v_permlane32_swap_b32 v92, v93
    v_max_f32 v92, v92, v93
    v_mul_f32 v117, -v92, v236
    v_mov_b32 v116, v117
    s_nop 1
    v_permlane32_swap_b32 v116, v117
    v_pk_fma_f32 v[160:161], v[128:129], v[236:237], v[116:117] op_sel_hi:[1,0,0]
    v_pk_fma_f32 v[162:163], v[130:131], v[236:237], v[116:117] op_sel_hi:[1,0,0]
    v_pk_fma_f32 v[128:129], v[128:129], v[236:237], v[116:117] op_sel:[0,0,1] op_sel_hi:[1,0,1] neg_lo:[1,0,0] neg_hi:[1,0,0]
    v_pk_fma_f32 v[130:131], v[130:131], v[236:237], v[116:117] op_sel:[0,0,1] op_sel_hi:[1,0,1] neg_lo:[1,0,0] neg_hi:[1,0,0]
    v_pk_fma_f32 v[164:165], v[132:133], v[236:237], v[116:117] op_sel_hi:[1,0,0]
    v_pk_fma_f32 v[132:133], v[132:133], v[236:237], v[116:117] op_sel:[0,0,1] op_sel_hi:[1,0,1] neg_lo:[1,0,0] neg_hi:[1,0,0]
    v_exp_f32 v160, v160
    v_exp_f32 v161, v161
    v_exp_f32 v162, v162
    v_exp_f32 v163, v163
    v_exp_f32 v128, v128
    v_exp_f32 v129, v129
    v_exp_f32 v130, v130
    v_exp_f32 v131, v131
    v_pk_fma_f32 v[166:167], v[134:135], v[236:237], v[116:117] op_sel_hi:[1,0,0]
    v_pk_fma_f32 v[134:135], v[134:135], v[236:237], v[116:117] op_sel:[0,0,1] op_sel_hi:[1,0,1] neg_lo:[1,0,0] neg_hi:[1,0,0]
    v_exp_f32 v164, v164
    v_exp_f32 v165, v165
    v_exp_f32 v132, v132
    v_exp_f32 v133, v133
    v_pk_fma_f32 v[168:169], v[136:137], v[236:237], v[116:117] op_sel_hi:[1,0,0]
    v_pk_add_f32 v[92:93], v[160:161], v[162:163]
    v_pk_add_f32 v[94:95], v[128:129], v[130:131]
    v_pk_fma_f32 v[136:137], v[136:137], v[236:237], v[116:117] op_sel:[0,0,1] op_sel_hi:[1,0,1] neg_lo:[1,0,0] neg_hi:[1,0,0]
    v_exp_f32 v166, v166
    v_exp_f32 v167, v167
    v_exp_f32 v134, v134
    v_exp_f32 v135, v135
    v_pk_fma_f32 v[170:171], v[138:139], v[236:237], v[116:117] op_sel_hi:[1,0,0]
    v_pk_add_f32 v[92:93], v[92:93], v[164:165]
    v_pk_add_f32 v[94:95], v[94:95], v[132:133]
    v_pk_fma_f32 v[138:139], v[138:139], v[236:237], v[116:117] op_sel:[0,0,1] op_sel_hi:[1,0,1] neg_lo:[1,0,0] neg_hi:[1,0,0]
    v_exp_f32 v168, v168
    v_exp_f32 v169, v169
    v_exp_f32 v136, v136
    v_exp_f32 v137, v137
    v_pk_fma_f32 v[172:173], v[140:141], v[236:237], v[116:117] op_sel_hi:[1,0,0]
    v_pk_add_f32 v[92:93], v[92:93], v[166:167]
    v_pk_add_f32 v[94:95], v[94:95], v[134:135]
    v_pk_fma_f32 v[140:141], v[140:141], v[236:237], v[116:117] op_sel:[0,0,1] op_sel_hi:[1,0,1] neg_lo:[1,0,0] neg_hi:[1,0,0]
    v_exp_f32 v170, v170
    v_exp_f32 v171, v171
    v_exp_f32 v138, v138
    v_exp_f32 v139, v139
    v_pk_fma_f32 v[174:175], v[142:143], v[236:237], v[116:117] op_sel_hi:[1,0,0]
    v_pk_add_f32 v[92:93], v[92:93], v[168:169]
    v_pk_add_f32 v[94:95], v[94:95], v[136:137]
    v_pk_fma_f32 v[142:143], v[142:143], v[236:237], v[116:117] op_sel:[0,0,1] op_sel_hi:[1,0,1] neg_lo:[1,0,0] neg_hi:[1,0,0]
    v_exp_f32 v172, v172
    v_exp_f32 v173, v173
    v_exp_f32 v140, v140
    v_exp_f32 v141, v141
    v_pk_add_f32 v[92:93], v[92:93], v[170:171]
    v_pk_add_f32 v[94:95], v[94:95], v[138:139]
    v_exp_f32 v174, v174
    v_exp_f32 v175, v175
    v_exp_f32 v142, v142
    v_exp_f32 v143, v143
    v_pk_add_f32 v[92:93], v[92:93], v[172:173]
    v_pk_add_f32 v[94:95], v[94:95], v[140:141]
    v_pk_add_f32 v[92:93], v[92:93], v[174:175]
    v_pk_add_f32 v[94:95], v[94:95], v[142:143]
    v_add_f32 v92, v92, v93
    v_add_f32 v94, v94, v95
    v_max3_f32 v89, -v144, -v145, -v146
    v_max3_f32 v88, v144, v145, v146
    v_permlane32_swap_b32 v92, v94
    v_add_f32 v92, v92, v94
    v_rcp_f32 v119, v92
    v_max3_f32 v89, v89, -v147, -v148
    v_max3_f32 v88, v88, v147, v148
    v_mov_b32 v118, v119
    v_max3_f32 v89, v89, -v149, -v150
    v_max3_f32 v88, v88, v149, v150
    v_permlane32_swap_b32 v118, v119
    v_pk_mul_f32 v[128:129], v[128:129], v[118:119] op_sel:[0,1]
    v_pk_mul_f32 v[130:131], v[130:131], v[118:119] op_sel:[0,1]
    v_cvt_pk_bf16_f32 v128, v128, v129
    v_pk_mul_f32 v[132:133], v[132:133], v[118:119] op_sel:[0,1]
    v_pk_mul_f32 v[134:135], v[134:135], v[118:119] op_sel:[0,1]
    v_cvt_pk_bf16_f32 v129, v130, v131
    ds_write_b64 v249, v[128:129] offset:64
    v_pk_mul_f32 v[136:137], v[136:137], v[118:119] op_sel:[0,1]
    v_pk_mul_f32 v[138:139], v[138:139], v[118:119] op_sel:[0,1]
    v_cvt_pk_bf16_f32 v130, v132, v133
    v_cvt_pk_bf16_f32 v131, v134, v135
    ds_write_b64 v249, v[130:131] offset:80
    v_pk_mul_f32 v[140:141], v[140:141], v[118:119] op_sel:[0,1]
    v_pk_mul_f32 v[142:143], v[142:143], v[118:119] op_sel:[0,1]
    v_cvt_pk_bf16_f32 v132, v136, v137
    v_cvt_pk_bf16_f32 v133, v138, v139
    ds_write_b64 v249, v[132:133] offset:96
    v_pk_mul_f32 v[160:161], v[160:161], v[118:119] op_sel_hi:[1,0]
    v_pk_mul_f32 v[162:163], v[162:163], v[118:119] op_sel_hi:[1,0]
    v_cvt_pk_bf16_f32 v134, v140, v141
    v_cvt_pk_bf16_f32 v135, v142, v143
    ds_write_b64 v249, v[134:135] offset:112
    v_pk_mul_f32 v[164:165], v[164:165], v[118:119] op_sel_hi:[1,0]
    v_pk_mul_f32 v[166:167], v[166:167], v[118:119] op_sel_hi:[1,0]
    v_cvt_pk_bf16_f32 v136, v160, v161
    v_cvt_pk_bf16_f32 v137, v162, v163
    v_max3_f32 v89, v89, -v151, -v152
    v_max3_f32 v88, v88, v151, v152
    ds_write_b64 v249, v[136:137] offset:0
    v_pk_mul_f32 v[168:169], v[168:169], v[118:119] op_sel_hi:[1,0]
    v_pk_mul_f32 v[170:171], v[170:171], v[118:119] op_sel_hi:[1,0]
    v_max3_f32 v89, v89, -v153, -v154
    v_cvt_pk_bf16_f32 v138, v164, v165
    v_cvt_pk_bf16_f32 v139, v166, v167
    v_max3_f32 v88, v88, v153, v154
    v_max3_f32 v89, v89, -v155, -v156
    ds_write_b64 v249, v[138:139] offset:16
    v_max3_f32 v88, v88, v155, v156
    v_pk_mul_f32 v[172:173], v[172:173], v[118:119] op_sel_hi:[1,0]
    v_pk_mul_f32 v[174:175], v[174:175], v[118:119] op_sel_hi:[1,0]
    v_cvt_pk_bf16_f32 v140, v168, v169
    v_cvt_pk_bf16_f32 v141, v170, v171
    v_max3_f32 v89, v89, -v157, -v158
    v_max3_f32 v88, v88, v157, v158
    ds_write_b64 v249, v[140:141] offset:32
    v_max_f32 v89, v89, -v159
    v_max_f32 v88, v88, v159
    v_cvt_pk_bf16_f32 v142, v172, v173
    v_cvt_pk_bf16_f32 v143, v174, v175
    ds_write_b64 v249, v[142:143] offset:48
    v_permlane32_swap_b32 v88, v89
    ds_read_b64_tr_b16 v[64:65], v251 offset:0
    ds_read_b64_tr_b16 v[66:67], v251 offset:544
    v_max_f32 v88, v88, v89
    ds_read_b64_tr_b16 v[68:69], v251 offset:2176
    v_mul_f32 v113, -v88, v237
    ds_read_b64_tr_b16 v[70:71], v251 offset:2720
    v_mov_b32 v112, v113
    ds_read_b64_tr_b16 v[40:41], v250 offset:0
    ds_read_b64_tr_b16 v[42:43], v250 offset:544
    ds_read_b64_tr_b16 v[44:45], v250 offset:2176
    v_permlane32_swap_b32 v112, v113
    ds_read_b64_tr_b16 v[46:47], v250 offset:2720
    v_pk_fma_f32 v[160:161], v[144:145], v[236:237], v[112:113] op_sel:[0,1,0] op_sel_hi:[1,1,0]
    v_pk_fma_f32 v[162:163], v[146:147], v[236:237], v[112:113] op_sel:[0,1,0] op_sel_hi:[1,1,0]
    v_pk_fma_f32 v[164:165], v[148:149], v[236:237], v[112:113] op_sel:[0,1,0] op_sel_hi:[1,1,0]
    v_pk_fma_f32 v[166:167], v[150:151], v[236:237], v[112:113] op_sel:[0,1,0] op_sel_hi:[1,1,0]
    v_pk_fma_f32 v[168:169], v[152:153], v[236:237], v[112:113] op_sel:[0,1,0] op_sel_hi:[1,1,0]
    v_pk_fma_f32 v[170:171], v[154:155], v[236:237], v[112:113] op_sel:[0,1,0] op_sel_hi:[1,1,0]
    v_pk_fma_f32 v[172:173], v[156:157], v[236:237], v[112:113] op_sel:[0,1,0] op_sel_hi:[1,1,0]
    v_pk_fma_f32 v[174:175], v[158:159], v[236:237], v[112:113] op_sel:[0,1,0] op_sel_hi:[1,1,0]
    v_pk_fma_f32 v[144:145], v[144:145], v[236:237], v[112:113] op_sel:[0,1,1] neg_lo:[1,0,0] neg_hi:[1,0,0]
    v_pk_fma_f32 v[146:147], v[146:147], v[236:237], v[112:113] op_sel:[0,1,1] neg_lo:[1,0,0] neg_hi:[1,0,0]
    v_pk_fma_f32 v[148:149], v[148:149], v[236:237], v[112:113] op_sel:[0,1,1] neg_lo:[1,0,0] neg_hi:[1,0,0]
    v_pk_fma_f32 v[150:151], v[150:151], v[236:237], v[112:113] op_sel:[0,1,1] neg_lo:[1,0,0] neg_hi:[1,0,0]
    v_pk_fma_f32 v[152:153], v[152:153], v[236:237], v[112:113] op_sel:[0,1,1] neg_lo:[1,0,0] neg_hi:[1,0,0]
    v_pk_fma_f32 v[154:155], v[154:155], v[236:237], v[112:113] op_sel:[0,1,1] neg_lo:[1,0,0] neg_hi:[1,0,0]
    v_pk_fma_f32 v[156:157], v[156:157], v[236:237], v[112:113] op_sel:[0,1,1] neg_lo:[1,0,0] neg_hi:[1,0,0]
    v_pk_fma_f32 v[158:159], v[158:159], v[236:237], v[112:113] op_sel:[0,1,1] neg_lo:[1,0,0] neg_hi:[1,0,0]
    s_waitcnt lgkmcnt(6)
    v_mfma_f32_32x32x16_bf16 v[128:143], v[64:67], v[48:51], 0
    v_exp_f32 v160, v160
    v_exp_f32 v161, v161
    v_exp_f32 v162, v162
    s_waitcnt lgkmcnt(4)
    v_mfma_f32_32x32x16_bf16 v[128:143], v[68:71], v[72:75], v[128:143]
    v_exp_f32 v163, v163
    v_exp_f32 v164, v164
    v_exp_f32 v165, v165
    v_mfma_f32_16x16x32_bf16 v[200:203], v[240:243], v[64:67], 0
    v_exp_f32 v166, v166
    v_mfma_f32_16x16x32_bf16 v[200:203], v[240:243], v[68:71], v[200:203]
    v_exp_f32 v167, v167
    s_waitcnt lgkmcnt(2)
    v_mfma_f32_32x32x16_bf16 v[176:191], v[40:43], v[48:51], 0
    v_exp_f32 v168, v168
    v_exp_f32 v169, v169
    v_exp_f32 v170, v170
    s_waitcnt lgkmcnt(0)
    v_mfma_f32_32x32x16_bf16 v[176:191], v[44:47], v[72:75], v[176:191]
    v_exp_f32 v171, v171
    v_exp_f32 v172, v172
    v_exp_f32 v173, v173
    v_mfma_f32_16x16x32_bf16 v[192:195], v[240:243], v[40:43], 0
    v_exp_f32 v174, v174
    v_mfma_f32_16x16x32_bf16 v[192:195], v[240:243], v[44:47], v[192:195]
    v_exp_f32 v175, v175
    v_exp_f32 v144, v144
    v_exp_f32 v145, v145
    v_exp_f32 v146, v146
    v_exp_f32 v147, v147
    v_exp_f32 v148, v148
    v_exp_f32 v149, v149
    v_exp_f32 v150, v150
    v_exp_f32 v151, v151
    v_exp_f32 v152, v152
    v_exp_f32 v153, v153
    v_exp_f32 v154, v154
    v_exp_f32 v155, v155
    v_exp_f32 v156, v156
    v_exp_f32 v157, v157
    v_exp_f32 v158, v158
    v_exp_f32 v159, v159
    v_pk_add_f32 v[88:89], v[160:161], v[162:163]
    v_pk_add_f32 v[90:91], v[144:145], v[146:147]
    v_pk_add_f32 v[88:89], v[88:89], v[164:165]
    v_pk_add_f32 v[90:91], v[90:91], v[148:149]
    v_pk_add_f32 v[88:89], v[88:89], v[166:167]
    v_pk_add_f32 v[90:91], v[90:91], v[150:151]
    v_pk_add_f32 v[88:89], v[88:89], v[168:169]
    v_pk_add_f32 v[90:91], v[90:91], v[152:153]
    v_pk_add_f32 v[88:89], v[88:89], v[170:171]
    v_pk_add_f32 v[90:91], v[90:91], v[154:155]
    v_pk_add_f32 v[88:89], v[88:89], v[172:173]
    v_pk_add_f32 v[90:91], v[90:91], v[156:157]
    v_pk_add_f32 v[88:89], v[88:89], v[174:175]
    v_pk_add_f32 v[90:91], v[90:91], v[158:159]
    v_add_f32 v88, v88, v89
    v_add_f32 v90, v90, v91
    v_pk_fma_f32 v[96:97], v[208:209], v[238:239], v[96:97] op_sel_hi:[1,0,1]
    v_pk_fma_f32 v[120:121], v[216:217], v[238:239], v[120:121] op_sel_hi:[1,0,1]
    v_permlane32_swap_b32 v88, v90
    v_add_f32 v88, v88, v90
    v_rcp_f32 v115, v88
    v_pk_fma_f32 v[98:99], v[210:211], v[238:239], v[98:99] op_sel_hi:[1,0,1]
    v_pk_fma_f32 v[122:123], v[218:219], v[238:239], v[122:123] op_sel_hi:[1,0,1]
    v_mov_b32 v114, v115
    v_pk_fma_f32 v[100:101], v[208:209], v[238:239], v[100:101] op_sel:[0,1,0]
    v_pk_fma_f32 v[102:103], v[210:211], v[238:239], v[102:103] op_sel:[0,1,0]
    v_permlane32_swap_b32 v114, v115
    v_pk_mul_f32 v[144:145], v[144:145], v[114:115] op_sel:[0,1]
    v_pk_mul_f32 v[146:147], v[146:147], v[114:115] op_sel:[0,1]
    v_cvt_pk_bf16_f32 v144, v144, v145
    v_pk_mul_f32 v[148:149], v[148:149], v[114:115] op_sel:[0,1]
    v_pk_mul_f32 v[150:151], v[150:151], v[114:115] op_sel:[0,1]
    v_cvt_pk_bf16_f32 v145, v146, v147
    ds_write_b64 v249, v[144:145] offset:64
    v_pk_mul_f32 v[152:153], v[152:153], v[114:115] op_sel:[0,1]
    v_pk_mul_f32 v[154:155], v[154:155], v[114:115] op_sel:[0,1]
    v_cvt_pk_bf16_f32 v146, v148, v149
    v_cvt_pk_bf16_f32 v147, v150, v151
    ds_write_b64 v249, v[146:147] offset:80
    v_pk_mul_f32 v[156:157], v[156:157], v[114:115] op_sel:[0,1]
    v_pk_mul_f32 v[158:159], v[158:159], v[114:115] op_sel:[0,1]
    v_cvt_pk_bf16_f32 v148, v152, v153
    v_cvt_pk_bf16_f32 v149, v154, v155
    ds_write_b64 v249, v[148:149] offset:96
    v_pk_mul_f32 v[160:161], v[160:161], v[114:115] op_sel_hi:[1,0]
    v_pk_mul_f32 v[162:163], v[162:163], v[114:115] op_sel_hi:[1,0]
    v_cvt_pk_bf16_f32 v150, v156, v157
    v_cvt_pk_bf16_f32 v151, v158, v159
    ds_write_b64 v249, v[150:151] offset:112
    v_pk_mul_f32 v[164:165], v[164:165], v[114:115] op_sel_hi:[1,0]
    v_pk_mul_f32 v[166:167], v[166:167], v[114:115] op_sel_hi:[1,0]
    v_cvt_pk_bf16_f32 v152, v160, v161
    v_cvt_pk_bf16_f32 v153, v162, v163
    ds_write_b64 v249, v[152:153] offset:0
    v_pk_mul_f32 v[168:169], v[168:169], v[114:115] op_sel_hi:[1,0]
    v_pk_mul_f32 v[170:171], v[170:171], v[114:115] op_sel_hi:[1,0]
    v_cvt_pk_bf16_f32 v154, v164, v165
    v_cvt_pk_bf16_f32 v155, v166, v167
    ds_write_b64 v249, v[154:155] offset:16
    v_pk_mul_f32 v[172:173], v[172:173], v[114:115] op_sel_hi:[1,0]
    v_pk_mul_f32 v[174:175], v[174:175], v[114:115] op_sel_hi:[1,0]
    v_cvt_pk_bf16_f32 v156, v168, v169
    v_cvt_pk_bf16_f32 v157, v170, v171
    ds_write_b64 v249, v[156:157] offset:32
    v_cvt_pk_bf16_f32 v158, v172, v173
    v_cvt_pk_bf16_f32 v159, v174, v175
    ds_write_b64 v249, v[158:159] offset:48
    ds_read_b64_tr_b16 v[64:65], v251 offset:0
    ds_read_b64_tr_b16 v[66:67], v251 offset:544
    ds_read_b64_tr_b16 v[68:69], v251 offset:2176
    ds_read_b64_tr_b16 v[70:71], v251 offset:2720
    ds_read_b64_tr_b16 v[40:41], v250 offset:0
    ds_read_b64_tr_b16 v[42:43], v250 offset:544
    ds_read_b64_tr_b16 v[44:45], v250 offset:2176
    ds_read_b64_tr_b16 v[46:47], v250 offset:2720
    v_pk_fma_f32 v[124:125], v[216:217], v[238:239], v[124:125] op_sel:[0,1,0]
    v_pk_fma_f32 v[126:127], v[218:219], v[238:239], v[126:127] op_sel:[0,1,0]
    v_pk_mul_f32 v[96:97], v[96:97], v[212:213]
    v_pk_mul_f32 v[120:121], v[120:121], v[220:221]
    v_pk_mul_f32 v[98:99], v[98:99], v[214:215]
    v_pk_mul_f32 v[122:123], v[122:123], v[222:223]
    v_pk_mul_f32 v[100:101], v[100:101], v[212:213]
    v_pk_mul_f32 v[102:103], v[102:103], v[214:215]
    v_pk_mul_f32 v[124:125], v[124:125], v[220:221]
    v_pk_mul_f32 v[126:127], v[126:127], v[222:223]
    v_cvt_pk_bf16_f32 v96, v96, v97
    v_cvt_pk_bf16_f32 v120, v120, v121
    v_cvt_pk_bf16_f32 v97, v98, v99
    v_cvt_pk_bf16_f32 v121, v122, v123
    v_cvt_pk_bf16_f32 v98, v100, v101
    v_cvt_pk_bf16_f32 v99, v102, v103
    v_cvt_pk_bf16_f32 v122, v124, v125
    v_cvt_pk_bf16_f32 v123, v126, v127
    v_permlane16_swap_b32 v96, v98
    v_permlane16_swap_b32 v97, v99
    v_permlane16_swap_b32 v120, v122
    v_permlane16_swap_b32 v121, v123
    s_waitcnt lgkmcnt(6)
    v_mfma_f32_32x32x16_bf16 v[128:143], v[64:67], v[96:99], v[128:143]
    s_waitcnt lgkmcnt(4)
    v_mfma_f32_32x32x16_bf16 v[128:143], v[68:71], v[120:123], v[128:143]
    s_mov_b32 vcc_lo, 0xffff0000
    s_mov_b32 vcc_hi, 0xffff0000
    v_mfma_f32_16x16x32_bf16 v[200:203], v[240:243], v[64:67], v[200:203]
    v_mfma_f32_16x16x32_bf16 v[200:203], v[240:243], v[68:71], v[200:203]
    s_waitcnt lgkmcnt(2)
    v_mfma_f32_32x32x16_bf16 v[176:191], v[40:43], v[96:99], v[176:191]
    s_waitcnt lgkmcnt(0)
    v_mfma_f32_32x32x16_bf16 v[176:191], v[44:47], v[120:123], v[176:191]
    s_nop 3
    ds_write_b128 v253, v[128:131] offset:0
    ds_write_b128 v253, v[132:135] offset:1024
    ds_write_b128 v253, v[136:139] offset:2048
    ds_write_b128 v253, v[140:143] offset:3072
    v_cndmask_b32 v200, v200, v201, vcc
    ds_write_b32 v253, v200 offset:4096
    v_mfma_f32_16x16x32_bf16 v[192:195], v[240:243], v[40:43], v[192:195]
    v_mfma_f32_16x16x32_bf16 v[192:195], v[240:243], v[44:47], v[192:195]
    s_waitcnt lgkmcnt(0)
    s_barrier
    ds_read_b32 v238, v254 offset:4096
    ds_read_b128 v[160:163], v254 offset:0
    ds_read_b128 v[164:167], v254 offset:1024
    ds_read_b128 v[168:171], v254 offset:2048
    ds_read_b128 v[172:175], v254 offset:3072
    s_nop 0
    v_cndmask_b32 v192, v192, v193, vcc
    s_waitcnt lgkmcnt(4)
    v_add_f32 v192, v192, v238
    s_waitcnt lgkmcnt(3)
    v_pk_add_f32 v[176:177], v[176:177], v[160:161]
    v_pk_add_f32 v[178:179], v[178:179], v[162:163]
    v_mov_b32_dpp v195, v192 quad_perm:[1,0,3,2] row_mask:0xf bank_mask:0xf
    s_waitcnt lgkmcnt(2)
    v_pk_add_f32 v[180:181], v[180:181], v[164:165]
    v_pk_add_f32 v[182:183], v[182:183], v[166:167]
    v_cvt_pk_bf16_f32 v176, v176, v177
    v_cvt_pk_bf16_f32 v177, v178, v179
    v_cvt_pk_bf16_f32 v178, v180, v181
    v_cvt_pk_bf16_f32 v179, v182, v183
    buffer_store_dwordx4 v[176:179], v2, s[24:27], s82 offen offset:0 sc1
    v_cvt_pk_bf16_f32 v192, v192, v195
    s_waitcnt lgkmcnt(1)
    v_pk_add_f32 v[184:185], v[184:185], v[168:169]
    v_pk_add_f32 v[186:187], v[186:187], v[170:171]
    s_waitcnt lgkmcnt(0)
    v_pk_add_f32 v[188:189], v[188:189], v[172:173]
    v_pk_add_f32 v[190:191], v[190:191], v[174:175]
    buffer_store_dword v192, v252, s[24:27], s83 offen sc1
    v_cvt_pk_bf16_f32 v184, v184, v185
    v_cvt_pk_bf16_f32 v185, v186, v187
    v_cvt_pk_bf16_f32 v186, v188, v189
    v_cvt_pk_bf16_f32 v187, v190, v191
    buffer_store_dwordx4 v[184:187], v2, s[24:27], s82 offen offset:1024 sc1
    ds_read_b128 v[208:211], v8 offset:0
    ds_read_b128 v[212:215], v8 offset:64
    v_and_b32 v197, 2, v1
    v_lshrrev_b32 v196, 5, v1
    v_lshlrev_b32 v197, 5, v197
    v_lshl_add_u32 v252, v196, 4, v197
    v_not_b32 v197, v240
    v_and_b32 v197, 0x20000000, v197
    v_lshl_or_b32 v252, v197, 1, v252
    v_bfe_u32 v197, v1, 4, 1
    v_lshlrev_b32 v197, 15, v197
    v_lshl_add_u32 v197, v196, 8, v197
    v_and_b32 v196, 15, v1
    v_lshl_add_u32 v249, v196, 4, v197
    s_add_u32 s82, s79, 65536
    s_waitcnt lgkmcnt(1)
    v_pk_fma_f32 v[32:33], v[208:209], v[232:233], v[32:33] op_sel_hi:[1,0,1]
    v_pk_fma_f32 v[56:57], v[208:209], v[232:233], v[56:57] op_sel:[0,1,0]
    v_pk_fma_f32 v[34:35], v[210:211], v[232:233], v[34:35] op_sel_hi:[1,0,1]
    v_pk_fma_f32 v[58:59], v[210:211], v[232:233], v[58:59] op_sel:[0,1,0]
    s_waitcnt lgkmcnt(0)
    v_pk_fma_f32 v[36:37], v[212:213], v[232:233], v[36:37] op_sel_hi:[1,0,1]
    v_pk_fma_f32 v[38:39], v[214:215], v[232:233], v[38:39] op_sel_hi:[1,0,1]
    v_pk_fma_f32 v[60:61], v[212:213], v[232:233], v[60:61] op_sel:[0,1,0]
    v_pk_fma_f32 v[62:63], v[214:215], v[232:233], v[62:63] op_sel:[0,1,0]
    v_cvt_pk_bf16_f32 v32, v32, v33
    v_cvt_pk_bf16_f32 v56, v56, v57
    v_cvt_pk_bf16_f32 v33, v34, v35
    v_cvt_pk_bf16_f32 v57, v58, v59
    v_cvt_pk_bf16_f32 v34, v36, v37
    v_cvt_pk_bf16_f32 v35, v38, v39
    v_cvt_pk_bf16_f32 v58, v60, v61
    v_cvt_pk_bf16_f32 v59, v62, v63
    v_permlane16_swap_b32 v32, v56
    v_permlane16_swap_b32 v33, v57
    v_permlane16_swap_b32 v34, v58
    v_permlane16_swap_b32 v35, v59
    v_pk_fma_f32 v[80:81], v[208:209], v[234:235], v[80:81] op_sel_hi:[1,0,1]
    v_pk_fma_f32 v[104:105], v[208:209], v[234:235], v[104:105] op_sel:[0,1,0]
    v_mfma_f32_32x32x16_bf16 v[128:143], v[224:227], v[32:35], 0
    v_cvt_pk_bf16_f32 v80, v80, v81
    v_cvt_pk_bf16_f32 v104, v104, v105
    s_nop 1
    v_permlane16_swap_b32 v80, v104
    v_mfma_f32_32x32x16_bf16 v[128:143], v[228:231], v[56:59], v[128:143]
    v_pk_fma_f32 v[82:83], v[210:211], v[234:235], v[82:83] op_sel_hi:[1,0,1]
    v_pk_fma_f32 v[106:107], v[210:211], v[234:235], v[106:107] op_sel:[0,1,0]
    v_pk_fma_f32 v[84:85], v[212:213], v[234:235], v[84:85] op_sel_hi:[1,0,1]
    v_pk_fma_f32 v[86:87], v[214:215], v[234:235], v[86:87] op_sel_hi:[1,0,1]
    s_nop 7
    v_max3_f32 v93, -v128, -v129, -v130
    v_max3_f32 v92, v128, v129, v130
    v_max3_f32 v93, v93, -v131, -v132
    v_max3_f32 v92, v92, v131, v132
    v_max3_f32 v93, v93, -v133, -v134
    v_max3_f32 v92, v92, v133, v134
    v_max3_f32 v93, v93, -v135, -v136
    v_max3_f32 v92, v92, v135, v136
    v_max3_f32 v93, v93, -v137, -v138
    v_max3_f32 v92, v92, v137, v138
    v_max3_f32 v93, v93, -v139, -v140
    v_max3_f32 v92, v92, v139, v140
    v_max3_f32 v93, v93, -v141, -v142
    v_max3_f32 v92, v92, v141, v142
    s_barrier
    v_max_f32 v93, v93, -v143
    v_max_f32 v92, v92, v143
    v_pk_fma_f32 v[108:109], v[212:213], v[234:235], v[108:109] op_sel:[0,1,0]
    v_pk_fma_f32 v[110:111], v[214:215], v[234:235], v[110:111] op_sel:[0,1,0]
    v_permlane32_swap_b32 v92, v93
    v_cvt_pk_bf16_f32 v81, v82, v83
    v_cvt_pk_bf16_f32 v105, v106, v107
    v_cvt_pk_bf16_f32 v82, v84, v85
    v_cvt_pk_bf16_f32 v83, v86, v87
    v_cvt_pk_bf16_f32 v106, v108, v109
    v_cvt_pk_bf16_f32 v107, v110, v111
    v_max_f32 v92, v92, v93
    v_mul_f32 v117, -v92, v236
    v_mov_b32 v116, v117
    v_permlane16_swap_b32 v81, v105
    v_permlane16_swap_b32 v82, v106
    v_permlane16_swap_b32 v83, v107
    v_permlane32_swap_b32 v116, v117
    s_nop 0
    v_mfma_f32_32x32x16_bf16 v[144:159], v[224:227], v[80:83], 0
    v_mfma_f32_32x32x16_bf16 v[144:159], v[228:231], v[104:107], v[144:159]
    v_pk_fma_f32 v[160:161], v[128:129], v[236:237], v[116:117] op_sel_hi:[1,0,0]
    v_pk_fma_f32 v[162:163], v[130:131], v[236:237], v[116:117] op_sel_hi:[1,0,0]
    v_pk_fma_f32 v[128:129], v[128:129], v[236:237], v[116:117] op_sel:[0,0,1] op_sel_hi:[1,0,1] neg_lo:[1,0,0] neg_hi:[1,0,0]
    v_pk_fma_f32 v[130:131], v[130:131], v[236:237], v[116:117] op_sel:[0,0,1] op_sel_hi:[1,0,1] neg_lo:[1,0,0] neg_hi:[1,0,0]
    v_pk_fma_f32 v[164:165], v[132:133], v[236:237], v[116:117] op_sel_hi:[1,0,0]
    v_pk_fma_f32 v[132:133], v[132:133], v[236:237], v[116:117] op_sel:[0,0,1] op_sel_hi:[1,0,1] neg_lo:[1,0,0] neg_hi:[1,0,0]
    v_exp_f32 v160, v160
    v_exp_f32 v161, v161
    v_exp_f32 v162, v162
    v_exp_f32 v163, v163
    v_exp_f32 v128, v128
    v_exp_f32 v129, v129
    v_exp_f32 v130, v130
    v_exp_f32 v131, v131
    v_pk_fma_f32 v[166:167], v[134:135], v[236:237], v[116:117] op_sel_hi:[1,0,0]
    v_pk_fma_f32 v[134:135], v[134:135], v[236:237], v[116:117] op_sel:[0,0,1] op_sel_hi:[1,0,1] neg_lo:[1,0,0] neg_hi:[1,0,0]
    v_exp_f32 v164, v164
    v_exp_f32 v165, v165
    v_exp_f32 v132, v132
    v_exp_f32 v133, v133
    v_pk_fma_f32 v[168:169], v[136:137], v[236:237], v[116:117] op_sel_hi:[1,0,0]
    v_pk_add_f32 v[92:93], v[160:161], v[162:163]
    v_pk_add_f32 v[94:95], v[128:129], v[130:131]
    v_pk_fma_f32 v[136:137], v[136:137], v[236:237], v[116:117] op_sel:[0,0,1] op_sel_hi:[1,0,1] neg_lo:[1,0,0] neg_hi:[1,0,0]
    v_exp_f32 v166, v166
    v_exp_f32 v167, v167
    v_exp_f32 v134, v134
    v_exp_f32 v135, v135
    v_pk_fma_f32 v[170:171], v[138:139], v[236:237], v[116:117] op_sel_hi:[1,0,0]
    v_pk_add_f32 v[92:93], v[92:93], v[164:165]
    v_pk_add_f32 v[94:95], v[94:95], v[132:133]
    v_pk_fma_f32 v[138:139], v[138:139], v[236:237], v[116:117] op_sel:[0,0,1] op_sel_hi:[1,0,1] neg_lo:[1,0,0] neg_hi:[1,0,0]
    v_exp_f32 v168, v168
    v_exp_f32 v169, v169
    v_exp_f32 v136, v136
    v_exp_f32 v137, v137
    v_pk_fma_f32 v[172:173], v[140:141], v[236:237], v[116:117] op_sel_hi:[1,0,0]
    v_pk_add_f32 v[92:93], v[92:93], v[166:167]
    v_pk_add_f32 v[94:95], v[94:95], v[134:135]
    v_pk_fma_f32 v[140:141], v[140:141], v[236:237], v[116:117] op_sel:[0,0,1] op_sel_hi:[1,0,1] neg_lo:[1,0,0] neg_hi:[1,0,0]
    v_exp_f32 v170, v170
    v_exp_f32 v171, v171
    v_exp_f32 v138, v138
    v_exp_f32 v139, v139
    v_pk_fma_f32 v[174:175], v[142:143], v[236:237], v[116:117] op_sel_hi:[1,0,0]
    v_pk_add_f32 v[92:93], v[92:93], v[168:169]
    v_pk_add_f32 v[94:95], v[94:95], v[136:137]
    v_pk_fma_f32 v[142:143], v[142:143], v[236:237], v[116:117] op_sel:[0,0,1] op_sel_hi:[1,0,1] neg_lo:[1,0,0] neg_hi:[1,0,0]
    v_exp_f32 v172, v172
    v_exp_f32 v173, v173
    v_exp_f32 v140, v140
    v_exp_f32 v141, v141
    v_pk_add_f32 v[92:93], v[92:93], v[170:171]
    v_pk_add_f32 v[94:95], v[94:95], v[138:139]
    v_exp_f32 v174, v174
    v_exp_f32 v175, v175
    v_exp_f32 v142, v142
    v_exp_f32 v143, v143
    v_pk_add_f32 v[92:93], v[92:93], v[172:173]
    v_pk_add_f32 v[94:95], v[94:95], v[140:141]
    v_pk_add_f32 v[92:93], v[92:93], v[174:175]
    v_pk_add_f32 v[94:95], v[94:95], v[142:143]
    v_add_f32 v92, v92, v93
    v_add_f32 v94, v94, v95
    v_max3_f32 v89, -v144, -v145, -v146
    v_max3_f32 v88, v144, v145, v146
    v_max3_f32 v89, v89, -v147, -v148
    v_max3_f32 v88, v88, v147, v148
    v_permlane32_swap_b32 v92, v94
    v_max3_f32 v89, v89, -v149, -v150
    v_max3_f32 v88, v88, v149, v150
    v_max3_f32 v89, v89, -v151, -v152
    v_add_f32 v92, v92, v94
    v_max3_f32 v88, v88, v151, v152
    v_rcp_f32 v119, v92
    v_max3_f32 v89, v89, -v153, -v154
    v_max3_f32 v88, v88, v153, v154
    v_max3_f32 v89, v89, -v155, -v156
    v_max3_f32 v88, v88, v155, v156
    v_max3_f32 v89, v89, -v157, -v158
    v_max3_f32 v88, v88, v157, v158
    v_max_f32 v89, v89, -v159
    v_mov_b32 v118, v119
    v_max_f32 v88, v88, v159
    s_nop 0
    v_permlane32_swap_b32 v118, v119
    v_permlane32_swap_b32 v88, v89
    v_pk_mul_f32 v[128:129], v[128:129], v[118:119] op_sel:[0,1]
    v_max_f32 v88, v88, v89
    v_pk_mul_f32 v[130:131], v[130:131], v[118:119] op_sel:[0,1]
    v_mul_f32 v113, -v88, v237
    v_pk_mul_f32 v[132:133], v[132:133], v[118:119] op_sel:[0,1]
    v_cvt_pk_bf16_f32 v128, v128, v129
    v_mov_b32 v112, v113
    v_pk_mul_f32 v[136:137], v[136:137], v[118:119] op_sel:[0,1]
    v_cvt_pk_bf16_f32 v129, v130, v131
    v_pk_mul_f32 v[160:161], v[160:161], v[118:119] op_sel_hi:[1,0]
    v_pk_mul_f32 v[162:163], v[162:163], v[118:119] op_sel_hi:[1,0]
    v_cvt_pk_bf16_f32 v130, v132, v133
    v_pk_mul_f32 v[138:139], v[138:139], v[118:119] op_sel:[0,1]
    v_cvt_pk_bf16_f32 v132, v136, v137
    v_permlane32_swap_b32 v112, v113
    v_pk_mul_f32 v[164:165], v[164:165], v[118:119] op_sel_hi:[1,0]
    v_cvt_pk_bf16_f32 v136, v160, v161
    v_cvt_pk_bf16_f32 v137, v162, v163
    v_pk_fma_f32 v[160:161], v[144:145], v[236:237], v[112:113] op_sel:[0,1,0] op_sel_hi:[1,1,0]
    v_pk_fma_f32 v[162:163], v[146:147], v[236:237], v[112:113] op_sel:[0,1,0] op_sel_hi:[1,1,0]
    v_cvt_pk_bf16_f32 v133, v138, v139
    v_pk_fma_f32 v[144:145], v[144:145], v[236:237], v[112:113] op_sel:[0,1,1] neg_lo:[1,0,0] neg_hi:[1,0,0]
    v_pk_fma_f32 v[146:147], v[146:147], v[236:237], v[112:113] op_sel:[0,1,1] neg_lo:[1,0,0] neg_hi:[1,0,0]
    v_pk_mul_f32 v[166:167], v[166:167], v[118:119] op_sel_hi:[1,0]
    v_cvt_pk_bf16_f32 v138, v164, v165
    v_pk_mul_f32 v[134:135], v[134:135], v[118:119] op_sel:[0,1]
    v_pk_fma_f32 v[164:165], v[148:149], v[236:237], v[112:113] op_sel:[0,1,0] op_sel_hi:[1,1,0]
    v_pk_mul_f32 v[140:141], v[140:141], v[118:119] op_sel:[0,1]
    v_pk_fma_f32 v[148:149], v[148:149], v[236:237], v[112:113] op_sel:[0,1,1] neg_lo:[1,0,0] neg_hi:[1,0,0]
    v_exp_f32 v160, v160
    v_exp_f32 v161, v161
    v_exp_f32 v162, v162
    v_exp_f32 v163, v163
    v_exp_f32 v144, v144
    v_exp_f32 v145, v145
    v_exp_f32 v146, v146
    v_exp_f32 v147, v147
    v_pk_mul_f32 v[168:169], v[168:169], v[118:119] op_sel_hi:[1,0]
    v_cvt_pk_bf16_f32 v139, v166, v167
    v_cvt_pk_bf16_f32 v131, v134, v135
    v_pk_fma_f32 v[166:167], v[150:151], v[236:237], v[112:113] op_sel:[0,1,0] op_sel_hi:[1,1,0]
    v_cvt_pk_bf16_f32 v134, v140, v141
    v_pk_fma_f32 v[150:151], v[150:151], v[236:237], v[112:113] op_sel:[0,1,1] neg_lo:[1,0,0] neg_hi:[1,0,0]
    v_exp_f32 v164, v164
    v_exp_f32 v165, v165
    v_exp_f32 v148, v148
    v_exp_f32 v149, v149
    v_pk_mul_f32 v[170:171], v[170:171], v[118:119] op_sel_hi:[1,0]
    v_cvt_pk_bf16_f32 v140, v168, v169
    v_pk_fma_f32 v[168:169], v[152:153], v[236:237], v[112:113] op_sel:[0,1,0] op_sel_hi:[1,1,0]
    v_pk_mul_f32 v[142:143], v[142:143], v[118:119] op_sel:[0,1]
    v_pk_add_f32 v[88:89], v[160:161], v[162:163]
    v_pk_add_f32 v[90:91], v[144:145], v[146:147]
    v_pk_fma_f32 v[152:153], v[152:153], v[236:237], v[112:113] op_sel:[0,1,1] neg_lo:[1,0,0] neg_hi:[1,0,0]
    v_exp_f32 v166, v166
    v_exp_f32 v167, v167
    v_exp_f32 v150, v150
    v_exp_f32 v151, v151
    v_pk_mul_f32 v[172:173], v[172:173], v[118:119] op_sel_hi:[1,0]
    v_cvt_pk_bf16_f32 v141, v170, v171
    v_pk_fma_f32 v[170:171], v[154:155], v[236:237], v[112:113] op_sel:[0,1,0] op_sel_hi:[1,1,0]
    v_cvt_pk_bf16_f32 v135, v142, v143
    v_pk_add_f32 v[88:89], v[88:89], v[164:165]
    v_pk_add_f32 v[90:91], v[90:91], v[148:149]
    v_pk_fma_f32 v[154:155], v[154:155], v[236:237], v[112:113] op_sel:[0,1,1] neg_lo:[1,0,0] neg_hi:[1,0,0]
    v_exp_f32 v168, v168
    v_exp_f32 v169, v169
    v_exp_f32 v152, v152
    v_exp_f32 v153, v153
    v_pk_mul_f32 v[174:175], v[174:175], v[118:119] op_sel_hi:[1,0]
    v_cvt_pk_bf16_f32 v142, v172, v173
    v_pk_fma_f32 v[172:173], v[156:157], v[236:237], v[112:113] op_sel:[0,1,0] op_sel_hi:[1,1,0]
    v_pk_add_f32 v[88:89], v[88:89], v[166:167]
    v_pk_add_f32 v[90:91], v[90:91], v[150:151]
    v_pk_fma_f32 v[156:157], v[156:157], v[236:237], v[112:113] op_sel:[0,1,1] neg_lo:[1,0,0] neg_hi:[1,0,0]
    v_exp_f32 v170, v170
    v_exp_f32 v171, v171
    v_exp_f32 v154, v154
    v_exp_f32 v155, v155
    v_cvt_pk_bf16_f32 v143, v174, v175
    v_pk_fma_f32 v[174:175], v[158:159], v[236:237], v[112:113] op_sel:[0,1,0] op_sel_hi:[1,1,0]
    v_pk_add_f32 v[88:89], v[88:89], v[168:169]
    v_pk_add_f32 v[90:91], v[90:91], v[152:153]
    v_pk_fma_f32 v[158:159], v[158:159], v[236:237], v[112:113] op_sel:[0,1,1] neg_lo:[1,0,0] neg_hi:[1,0,0]
    v_exp_f32 v172, v172
    v_exp_f32 v173, v173
    v_exp_f32 v156, v156
    v_exp_f32 v157, v157
    v_pk_add_f32 v[88:89], v[88:89], v[170:171]
    v_pk_add_f32 v[90:91], v[90:91], v[154:155]
    v_exp_f32 v174, v174
    v_exp_f32 v175, v175
    v_exp_f32 v158, v158
    v_exp_f32 v159, v159
    v_pk_add_f32 v[88:89], v[88:89], v[172:173]
    v_pk_add_f32 v[90:91], v[90:91], v[156:157]
    v_pk_add_f32 v[88:89], v[88:89], v[174:175]
    v_pk_add_f32 v[90:91], v[90:91], v[158:159]
    v_add_f32 v88, v88, v89
    v_add_f32 v90, v90, v91
    s_nop 1
    v_permlane32_swap_b32 v88, v90
    v_add_f32 v88, v88, v90
    v_rcp_f32 v115, v88
    s_nop 0
    v_mov_b32 v114, v115
    s_nop 1
    v_permlane32_swap_b32 v114, v115
    v_pk_mul_f32 v[144:145], v[144:145], v[114:115] op_sel:[0,1]
    v_pk_mul_f32 v[146:147], v[146:147], v[114:115] op_sel:[0,1]
    v_pk_mul_f32 v[148:149], v[148:149], v[114:115] op_sel:[0,1]
    v_pk_mul_f32 v[150:151], v[150:151], v[114:115] op_sel:[0,1]
    v_cvt_pk_bf16_f32 v144, v144, v145
    v_pk_mul_f32 v[152:153], v[152:153], v[114:115] op_sel:[0,1]
    v_pk_mul_f32 v[154:155], v[154:155], v[114:115] op_sel:[0,1]
    v_pk_mul_f32 v[156:157], v[156:157], v[114:115] op_sel:[0,1]
    v_pk_mul_f32 v[158:159], v[158:159], v[114:115] op_sel:[0,1]
    v_cvt_pk_bf16_f32 v145, v146, v147
    v_pk_mul_f32 v[160:161], v[160:161], v[114:115] op_sel_hi:[1,0]
    v_pk_mul_f32 v[162:163], v[162:163], v[114:115] op_sel_hi:[1,0]
    v_pk_mul_f32 v[164:165], v[164:165], v[114:115] op_sel_hi:[1,0]
    v_pk_mul_f32 v[166:167], v[166:167], v[114:115] op_sel_hi:[1,0]
    v_pk_mul_f32 v[168:169], v[168:169], v[114:115] op_sel_hi:[1,0]
    v_pk_mul_f32 v[170:171], v[170:171], v[114:115] op_sel_hi:[1,0]
    v_pk_mul_f32 v[172:173], v[172:173], v[114:115] op_sel_hi:[1,0]
    v_pk_mul_f32 v[174:175], v[174:175], v[114:115] op_sel_hi:[1,0]
    v_cvt_pk_bf16_f32 v146, v148, v149
    v_cvt_pk_bf16_f32 v147, v150, v151
    v_cvt_pk_bf16_f32 v148, v152, v153
    v_cvt_pk_bf16_f32 v149, v154, v155
    v_cvt_pk_bf16_f32 v150, v156, v157
    v_cvt_pk_bf16_f32 v151, v158, v159
    v_cvt_pk_bf16_f32 v152, v160, v161
    v_cvt_pk_bf16_f32 v153, v162, v163
    v_cvt_pk_bf16_f32 v154, v164, v165
    v_cvt_pk_bf16_f32 v155, v166, v167
    v_cvt_pk_bf16_f32 v156, v168, v169
    v_cvt_pk_bf16_f32 v157, v170, v171
    v_cvt_pk_bf16_f32 v158, v172, v173
    v_cvt_pk_bf16_f32 v159, v174, v175
    s_barrier
    s_mov_b32 s60, 0
L_spin_3:
    buffer_load_dwordx4 v[160:163], v252, s[24:27], s80 offen offset:0 sc1
    buffer_load_dwordx4 v[164:167], v252, s[24:27], s80 offen offset:32 sc1
    buffer_load_dwordx4 v[176:179], v2, s[24:27], s81 offen offset:0 sc1
    buffer_load_dwordx4 v[180:183], v2, s[24:27], s81 offen offset:1024 sc1
    buffer_load_dwordx4 v[184:187], v2, s[24:27], s81 offen offset:2048 sc1
    buffer_load_dwordx4 v[188:191], v2, s[24:27], s81 offen offset:3072 sc1
    s_add_u32 s60, s60, 1
    s_cmp_lt_u32 s60, 300000
    s_cbranch_scc0 L_tmo_5
    s_waitcnt vmcnt(5)
    v_mfma_f32_16x16x32_bf16 v[48:51], v[160:163], v[136:139], 0
    v_max_u32 v196, v160, v161
    v_mfma_f32_16x16x32_bf16 v[64:67], v[160:163], v[128:131], 0
    v_max3_u32 v196, v196, v162, v163
    s_waitcnt vmcnt(4)
    v_mfma_f32_16x16x32_bf16 v[48:51], v[164:167], v[140:143], v[48:51]
    v_max3_u32 v196, v196, v164, v165
    v_mfma_f32_16x16x32_bf16 v[64:67], v[164:167], v[132:135], v[64:67]
    v_max3_u32 v196, v196, v166, v167
    s_waitcnt vmcnt(3)
    v_mfma_f32_32x32x16_bf16 v[32:47], v[176:179], v[136:139], 0
    v_max3_u32 v196, v196, v176, v177
    v_max3_u32 v196, v196, v178, v179
    s_waitcnt vmcnt(2)
    v_mfma_f32_32x32x16_bf16 v[32:47], v[180:183], v[140:143], v[32:47]
    v_max_u32 v197, v180, v181
    v_max3_u32 v197, v197, v182, v183
    s_waitcnt vmcnt(1)
    v_mfma_f32_32x32x16_bf16 v[32:47], v[184:187], v[128:131], v[32:47]
    v_max3_u32 v197, v197, v184, v185
    v_max3_u32 v197, v197, v186, v187
    s_waitcnt vmcnt(0)
    v_mfma_f32_32x32x16_bf16 v[32:47], v[188:191], v[132:135], v[32:47]
    v_max3_u32 v197, v197, v188, v189
    v_max3_u32 v197, v197, v190, v191
    v_max_u32 v196, v196, v197
    v_cmp_eq_u32 vcc, -1, v196
    s_cbranch_vccnz L_spin_3
L_done_7:
    v_mfma_f32_16x16x32_bf16 v[96:99], v[160:163], v[152:155], 0
    s_mov_b32 vcc_lo, 0xffff0000
    s_mov_b32 vcc_hi, 0xffff0000
    v_mfma_f32_16x16x32_bf16 v[112:115], v[160:163], v[144:147], 0
    v_add_f32 v48, v48, v66
    v_add_f32 v49, v49, v67
    v_mfma_f32_16x16x32_bf16 v[96:99], v[164:167], v[156:159], v[96:99]
    v_cndmask_b32 v48, v48, v49, vcc
    v_add_f32 v48, 0x358637bd, v48
    v_mfma_f32_16x16x32_bf16 v[112:115], v[164:167], v[148:151], v[112:115]
    v_rcp_f32 v48, v48
    v_mfma_f32_32x32x16_bf16 v[80:95], v[176:179], v[152:155], 0
    v_mul_f32 v32, v48, v32
    v_mul_f32 v33, v48, v33
    v_mul_f32 v34, v48, v34
    v_mul_f32 v35, v48, v35
    v_mul_f32 v40, v48, v40
    v_mul_f32 v41, v48, v41
    v_mfma_f32_32x32x16_bf16 v[80:95], v[180:183], v[156:159], v[80:95]
    v_mul_f32 v42, v48, v42
    v_mul_f32 v43, v48, v43
    v_cvt_pk_bf16_f32 v68, v32, v33
    v_cvt_pk_bf16_f32 v69, v34, v35
    v_cvt_pk_bf16_f32 v70, v40, v41
    v_cvt_pk_bf16_f32 v71, v42, v43
    v_mfma_f32_32x32x16_bf16 v[80:95], v[184:187], v[144:147], v[80:95]
    buffer_store_dwordx4 v[68:71], v249, s[24:27], s79 offen offset:0 sc1
    v_add_f32 v96, v96, v114
    v_add_f32 v97, v97, v115
    v_cndmask_b32 v96, v96, v97, vcc
    v_add_f32 v96, 0x358637bd, v96
    v_rcp_f32 v96, v96
    v_mfma_f32_32x32x16_bf16 v[80:95], v[188:191], v[148:151], v[80:95]
    v_mul_f32 v36, v48, v36
    v_mul_f32 v37, v48, v37
    v_mul_f32 v38, v48, v38
    v_mul_f32 v39, v48, v39
    v_mul_f32 v44, v48, v44
    v_mul_f32 v45, v48, v45
    v_mul_f32 v46, v48, v46
    v_mul_f32 v47, v48, v47
    v_cvt_pk_bf16_f32 v72, v36, v37
    v_cvt_pk_bf16_f32 v73, v38, v39
    v_cvt_pk_bf16_f32 v74, v44, v45
    v_cvt_pk_bf16_f32 v75, v46, v47
    buffer_store_dwordx4 v[72:75], v249, s[24:27], s79 offen offset:512 sc1
    v_pk_mul_f32 v[80:81], v[80:81], v[96:97] op_sel_hi:[1,0]
    v_pk_mul_f32 v[82:83], v[82:83], v[96:97] op_sel_hi:[1,0]
    v_pk_mul_f32 v[88:89], v[88:89], v[96:97] op_sel_hi:[1,0]
    v_pk_mul_f32 v[90:91], v[90:91], v[96:97] op_sel_hi:[1,0]
    v_cvt_pk_bf16_f32 v116, v80, v81
    v_cvt_pk_bf16_f32 v117, v82, v83
    v_cvt_pk_bf16_f32 v118, v88, v89
    v_cvt_pk_bf16_f32 v119, v90, v91
    buffer_store_dwordx4 v[116:119], v249, s[24:27], s82 offen offset:0 sc1
    v_pk_mul_f32 v[84:85], v[84:85], v[96:97] op_sel_hi:[1,0]
    v_pk_mul_f32 v[86:87], v[86:87], v[96:97] op_sel_hi:[1,0]
    v_pk_mul_f32 v[92:93], v[92:93], v[96:97] op_sel_hi:[1,0]
    v_pk_mul_f32 v[94:95], v[94:95], v[96:97] op_sel_hi:[1,0]
    v_cvt_pk_bf16_f32 v120, v84, v85
    v_cvt_pk_bf16_f32 v121, v86, v87
    v_cvt_pk_bf16_f32 v122, v92, v93
    v_cvt_pk_bf16_f32 v123, v94, v95
    buffer_store_dwordx4 v[120:123], v249, s[24:27], s82 offen offset:512 sc1
    s_branch L_ophase
L_epiB:
    v_mfma_f32_16x16x32_bf16 v[112:115], v[192:195], v[156:159], v[112:115]
    ds_read_b32 v219, v5 offset:192
    ds_read_b32 v223, v5 offset:704
    v_mfma_f32_16x16x32_bf16 v[116:119], v[196:199], v[156:159], v[116:119]
    ds_read_b128 v[224:227], v8 offset:1024
    ds_read_b128 v[228:231], v8 offset:1088
    v_mfma_f32_16x16x32_bf16 v[120:123], v[156:159], v[200:203], v[120:123]
    ds_read_b32 v232, v9 offset:1280
    ds_read_b32 v233, v9 offset:1344
    v_mfma_f32_16x16x32_bf16 v[124:127], v[156:159], v[204:207], v[124:127]
    ds_read_b128 v[208:211], v6 offset:192
    ds_read_b128 v[212:215], v6 offset:704
    v_mfma_f32_16x16x32_bf16 v[40:43], v[192:195], v[144:147], v[40:43]
    ds_read_b32 v216, v5 offset:0
    ds_read_b32 v220, v5 offset:512
    v_mfma_f32_16x16x32_bf16 v[44:47], v[196:199], v[144:147], v[44:47]
    ds_read_b32 v217, v5 offset:64
    ds_read_b32 v221, v5 offset:576
    v_mfma_f32_16x16x32_bf16 v[48:51], v[144:147], v[200:203], v[48:51]
    ds_read_b32 v218, v5 offset:128
    ds_read_b32 v222, v5 offset:640
    v_mfma_f32_16x16x32_bf16 v[52:55], v[144:147], v[204:207], v[52:55]
    s_waitcnt lgkmcnt(11)
    v_fmac_f32 v112, v224, v219
    v_fmac_f32 v113, v225, v219
    v_mfma_f32_16x16x32_bf16 v[64:67], v[192:195], v[148:151], v[64:67]
    v_fmac_f32 v114, v226, v219
    v_fmac_f32 v115, v227, v219
    v_mfma_f32_16x16x32_bf16 v[68:71], v[196:199], v[148:151], v[68:71]
    s_waitcnt lgkmcnt(10)
    v_fmac_f32 v116, v228, v219
    v_fmac_f32 v117, v229, v219
    v_mfma_f32_16x16x32_bf16 v[72:75], v[148:151], v[200:203], v[72:75]
    v_fmac_f32 v118, v230, v219
    v_fmac_f32 v119, v231, v219
    v_mfma_f32_16x16x32_bf16 v[76:79], v[148:151], v[204:207], v[76:79]
    v_mul_f32 v112, v223, v112
    v_mul_f32 v113, v223, v113
    v_mfma_f32_16x16x32_bf16 v[88:91], v[192:195], v[152:155], v[88:91]
    v_mul_f32 v114, v223, v114
    v_mul_f32 v115, v223, v115
    v_mfma_f32_16x16x32_bf16 v[92:95], v[196:199], v[152:155], v[92:95]
    v_mul_f32 v116, v223, v116
    v_mul_f32 v117, v223, v117
    v_mfma_f32_16x16x32_bf16 v[96:99], v[152:155], v[200:203], v[96:99]
    v_mul_f32 v118, v223, v118
    v_mul_f32 v119, v223, v119
    v_mfma_f32_16x16x32_bf16 v[100:103], v[152:155], v[204:207], v[100:103]
    v_cvt_pk_bf16_f32 v112, v112, v113
    v_cvt_pk_bf16_f32 v113, v114, v115
    v_mfma_f32_16x16x32_bf16 v[36:39], v[188:191], v[144:147], v[36:39]
    v_cvt_pk_bf16_f32 v114, v116, v117
    v_cvt_pk_bf16_f32 v115, v118, v119
    v_mfma_f32_16x16x32_bf16 v[60:63], v[188:191], v[148:151], v[60:63]
    s_waitcnt lgkmcnt(7)
    v_fmac_f32 v120, v208, v232
    v_fmac_f32 v121, v209, v232
    v_mfma_f32_16x16x32_bf16 v[84:87], v[188:191], v[152:155], v[84:87]
    v_fmac_f32 v122, v210, v232
    v_fmac_f32 v123, v211, v232
    v_mfma_f32_16x16x32_bf16 v[108:111], v[188:191], v[156:159], v[108:111]
    v_fmac_f32 v124, v208, v233
    v_fmac_f32 v125, v209, v233
    v_mfma_f32_16x16x32_bf16 v[80:83], v[184:187], v[152:155], v[80:83]
    v_fmac_f32 v126, v210, v233
    v_fmac_f32 v127, v211, v233
    v_mfma_f32_16x16x32_bf16 v[104:107], v[184:187], v[156:159], v[104:107]
    s_waitcnt lgkmcnt(6)
    v_mul_f32 v120, v212, v120
    v_mul_f32 v121, v213, v121
    v_mul_f32 v122, v214, v122
    v_mul_f32 v123, v215, v123
    v_mul_f32 v124, v212, v124
    v_mul_f32 v125, v213, v125
    v_mul_f32 v126, v214, v126
    v_mul_f32 v127, v215, v127
    v_cvt_pk_bf16_f32 v116, v120, v121
    v_cvt_pk_bf16_f32 v117, v122, v123
    v_cvt_pk_bf16_f32 v118, v124, v125
    v_cvt_pk_bf16_f32 v119, v126, v127
    buffer_store_dwordx4 v[112:115], v2, s[24:27], s81 offen offset:0 sc1
    buffer_store_dwordx4 v[116:119], v2, s[24:27], s81 offen offset:1024 sc1
    s_lshl_b32 s52, s50, 2
    s_add_u32 s52, s52, 0x26b10
    v_mov_b32 v234, s52
    v_mov_b32 v235, s51
    ds_read_b128 v[128:131], v8 offset:768
    ds_read_b128 v[132:135], v8 offset:832
    ds_read_b128 v[160:163], v6 offset:0
    ds_read_b128 v[164:167], v6 offset:512
    ds_read_b128 v[168:171], v6 offset:64
    ds_read_b128 v[172:175], v6 offset:576
    ds_read_b128 v[176:179], v6 offset:128
    ds_read_b128 v[180:183], v6 offset:640
    ds_write_b128 v253, v[112:115]
    ds_write_b128 v254, v[116:119]
    ds_write_b32 v234, v235
    s_waitcnt lgkmcnt(14)
    v_pk_fma_f32 v[40:41], v[224:225], v[216:217], v[40:41] op_sel_hi:[1,0,1]
    v_pk_fma_f32 v[64:65], v[224:225], v[216:217], v[64:65] op_sel:[0,1,0]
    s_waitcnt lgkmcnt(12)
    v_pk_fma_f32 v[88:89], v[224:225], v[218:219], v[88:89] op_sel_hi:[1,0,1]
    v_pk_fma_f32 v[42:43], v[226:227], v[216:217], v[42:43] op_sel_hi:[1,0,1]
    v_pk_fma_f32 v[66:67], v[226:227], v[216:217], v[66:67] op_sel:[0,1,0]
    v_pk_fma_f32 v[90:91], v[226:227], v[218:219], v[90:91] op_sel_hi:[1,0,1]
    v_pk_fma_f32 v[44:45], v[228:229], v[216:217], v[44:45] op_sel_hi:[1,0,1]
    v_pk_fma_f32 v[46:47], v[230:231], v[216:217], v[46:47] op_sel_hi:[1,0,1]
    v_pk_fma_f32 v[68:69], v[228:229], v[216:217], v[68:69] op_sel:[0,1,0]
    v_pk_fma_f32 v[70:71], v[230:231], v[216:217], v[70:71] op_sel:[0,1,0]
    v_pk_fma_f32 v[92:93], v[228:229], v[218:219], v[92:93] op_sel_hi:[1,0,1]
    v_pk_fma_f32 v[94:95], v[230:231], v[218:219], v[94:95] op_sel_hi:[1,0,1]
    v_pk_mul_f32 v[40:41], v[40:41], v[220:221] op_sel_hi:[1,0]
    v_pk_mul_f32 v[64:65], v[64:65], v[220:221] op_sel:[0,1]
    s_waitcnt lgkmcnt(11)
    v_pk_mul_f32 v[88:89], v[88:89], v[222:223] op_sel_hi:[1,0]
    s_waitcnt lgkmcnt(10)
    v_pk_fma_f32 v[56:57], v[128:129], v[216:217], v[56:57] op_sel:[0,1,0]
    v_pk_fma_f32 v[80:81], v[128:129], v[218:219], v[80:81] op_sel_hi:[1,0,1]
    v_pk_fma_f32 v[104:105], v[128:129], v[218:219], v[104:105] op_sel:[0,1,0]
    v_pk_mul_f32 v[42:43], v[42:43], v[220:221] op_sel_hi:[1,0]
    v_pk_mul_f32 v[66:67], v[66:67], v[220:221] op_sel:[0,1]
    v_pk_mul_f32 v[90:91], v[90:91], v[222:223] op_sel_hi:[1,0]
    v_pk_fma_f32 v[58:59], v[130:131], v[216:217], v[58:59] op_sel:[0,1,0]
    v_pk_fma_f32 v[82:83], v[130:131], v[218:219], v[82:83] op_sel_hi:[1,0,1]
    v_pk_fma_f32 v[106:107], v[130:131], v[218:219], v[106:107] op_sel:[0,1,0]
    v_pk_mul_f32 v[44:45], v[44:45], v[220:221] op_sel_hi:[1,0]
    v_pk_mul_f32 v[46:47], v[46:47], v[220:221] op_sel_hi:[1,0]
    v_pk_mul_f32 v[68:69], v[68:69], v[220:221] op_sel:[0,1]
    v_pk_mul_f32 v[70:71], v[70:71], v[220:221] op_sel:[0,1]
    v_pk_mul_f32 v[92:93], v[92:93], v[222:223] op_sel_hi:[1,0]
    v_pk_mul_f32 v[94:95], v[94:95], v[222:223] op_sel_hi:[1,0]
    s_waitcnt lgkmcnt(9)
    v_pk_fma_f32 v[60:61], v[132:133], v[216:217], v[60:61] op_sel:[0,1,0]
    v_pk_fma_f32 v[62:63], v[134:135], v[216:217], v[62:63] op_sel:[0,1,0]
    v_pk_fma_f32 v[84:85], v[132:133], v[218:219], v[84:85] op_sel_hi:[1,0,1]
    v_pk_fma_f32 v[86:87], v[134:135], v[218:219], v[86:87] op_sel_hi:[1,0,1]
    v_pk_fma_f32 v[108:109], v[132:133], v[218:219], v[108:109] op_sel:[0,1,0]
    v_pk_fma_f32 v[110:111], v[134:135], v[218:219], v[110:111] op_sel:[0,1,0]
    v_cvt_pk_bf16_f32 v40, v40, v41
    v_cvt_pk_bf16_f32 v64, v64, v65
    v_cvt_pk_bf16_f32 v88, v88, v89
    v_cvt_pk_bf16_f32 v56, v56, v57
    v_cvt_pk_bf16_f32 v80, v80, v81
    v_cvt_pk_bf16_f32 v104, v104, v105
    v_cvt_pk_bf16_f32 v41, v42, v43
    v_cvt_pk_bf16_f32 v65, v66, v67
    v_cvt_pk_bf16_f32 v89, v90, v91
    v_cvt_pk_bf16_f32 v57, v58, v59
    v_cvt_pk_bf16_f32 v81, v82, v83
    v_cvt_pk_bf16_f32 v105, v106, v107
    v_cvt_pk_bf16_f32 v42, v44, v45
    v_cvt_pk_bf16_f32 v43, v46, v47
    v_cvt_pk_bf16_f32 v66, v68, v69
    v_cvt_pk_bf16_f32 v67, v70, v71
    v_cvt_pk_bf16_f32 v90, v92, v93
    v_cvt_pk_bf16_f32 v91, v94, v95
    v_cvt_pk_bf16_f32 v58, v60, v61
    v_cvt_pk_bf16_f32 v59, v62, v63
    v_cvt_pk_bf16_f32 v82, v84, v85
    v_cvt_pk_bf16_f32 v83, v86, v87
    v_cvt_pk_bf16_f32 v106, v108, v109
    v_cvt_pk_bf16_f32 v107, v110, v111
    v_mfma_f32_16x16x32_bf16 v[60:63], v[40:43], v[56:59], v[236:239]
    v_mul_f32 v221, 0x3e8293ee, v221
    v_mul_f32 v222, 0x3e8293ee, v222
    v_mfma_f32_16x16x32_bf16 v[44:47], v[64:67], v[56:59], v[240:243]
    v_mul_f32 v223, 0x3e8293ee, v223
    v_mov_b64 v[192:193], v[116:117]
    v_mfma_f32_16x16x32_bf16 v[84:87], v[64:67], v[80:83], v[236:239]
    v_mov_b64 v[204:205], v[118:119]
    s_add_u32 s83, s79, 32768
    v_mfma_f32_16x16x32_bf16 v[68:71], v[88:91], v[80:83], v[240:243]
    s_add_u32 s81, s82, 32768
    v_mul_f32 v220, 0x3e8293ee, v220
    v_mfma_f32_16x16x32_bf16 v[108:111], v[88:91], v[104:107], v[236:239]
    v_max3_f32 v146, v60, v61, v44
    v_max3_f32 v147, v62, v63, v46
    v_mfma_f32_16x16x32_bf16 v[92:95], v[112:115], v[104:107], v[240:243]
    v_max_f32 v146, v146, v45
    v_max_f32 v147, v147, v47
    v_max3_f32 v148, v84, v85, v68
    v_max3_f32 v149, v86, v87, v70
    v_max_f32 v148, v148, v69
    v_max_f32 v149, v149, v71
    v_mul_f32 v146, v221, v146
    v_mul_f32 v147, v221, v147
    v_mul_f32 v148, v222, v148
    v_mul_f32 v149, v222, v149
    v_max3_f32 v150, v108, v109, v92
    v_max3_f32 v151, v110, v111, v94
    v_max_f32 v150, v150, v93
    v_max_f32 v151, v151, v95
    s_waitcnt lgkmcnt(0)
    s_cmp_eq_u32 s65, 0
    s_cbranch_scc0 L_hg_8
    buffer_load_dwordx4 v[136:139], v2, s[24:27], s80 offen offset:0 sc1
    buffer_load_dwordx4 v[140:143], v2, s[24:27], s80 offen offset:1024 sc1
L_hd_9:
    v_mul_f32 v150, v223, v150
    v_mul_f32 v151, v223, v151
    v_max_f32 v153, v146, v147
    v_max_f32 v154, v148, v149
    v_max_f32 v155, v150, v151
    v_pk_fma_f32 v[48:49], v[160:161], v[232:233], v[48:49] op_sel_hi:[1,0,1]
    v_permlane32_swap_b32 v152, v154
    v_permlane32_swap_b32 v153, v155
    v_max_f32 v152, v152, v154
    v_max_f32 v153, v153, v155
    v_pk_fma_f32 v[50:51], v[162:163], v[232:233], v[50:51] op_sel_hi:[1,0,1]
    v_pk_fma_f32 v[72:73], v[168:169], v[232:233], v[72:73] op_sel_hi:[1,0,1]
    v_permlane16_swap_b32 v152, v153
    v_max_f32 v153, v152, v153
    v_mov_b32 v152, v153
    v_pk_fma_f32 v[74:75], v[170:171], v[232:233], v[74:75] op_sel_hi:[1,0,1]
    v_pk_fma_f32 v[52:53], v[160:161], v[232:233], v[52:53] op_sel:[0,1,0]
    v_permlane16_swap_b32 v152, v153
    v_mov_b64 v[154:155], v[152:153]
    v_pk_fma_f32 v[54:55], v[162:163], v[232:233], v[54:55] op_sel:[0,1,0]
    v_pk_fma_f32 v[76:77], v[168:169], v[232:233], v[76:77] op_sel:[0,1,0]
    v_permlane32_swap_b32 v152, v154
    v_permlane32_swap_b32 v153, v155
    v_pk_add_f32 v[146:147], v[146:147], v[152:153] op_sel:[0,1] neg_lo:[0,1] neg_hi:[0,1]
    v_pk_add_f32 v[148:149], v[148:149], v[154:155] op_sel_hi:[1,0] neg_lo:[0,1] neg_hi:[0,1]
    v_pk_add_f32 v[150:151], v[150:151], v[154:155] op_sel:[0,1] neg_lo:[0,1] neg_hi:[0,1]
    v_exp_f32 v146, v146
    v_exp_f32 v147, v147
    v_exp_f32 v148, v148
    v_exp_f32 v149, v149
    v_exp_f32 v150, v150
    v_exp_f32 v151, v151
    v_add_f32 v153, v146, v147
    v_add_f32 v154, v148, v149
    v_add_f32 v155, v150, v151
    v_pk_fma_f32 v[78:79], v[170:171], v[232:233], v[78:79] op_sel:[0,1,0]
    v_permlane32_swap_b32 v152, v154
    v_permlane32_swap_b32 v153, v155
    v_add_f32 v152, v152, v154
    v_add_f32 v153, v153, v155
    v_pk_fma_f32 v[96:97], v[176:177], v[232:233], v[96:97] op_sel_hi:[1,0,1]
    v_pk_fma_f32 v[98:99], v[178:179], v[232:233], v[98:99] op_sel_hi:[1,0,1]
    v_permlane16_swap_b32 v152, v153
    v_add_f32 v153, v152, v153
    v_rcp_f32 v153, v153
    v_pk_mul_f32 v[48:49], v[48:49], v[164:165]
    v_pk_mul_f32 v[50:51], v[50:51], v[166:167]
    v_mov_b32 v152, v153
    v_pk_mul_f32 v[72:73], v[72:73], v[172:173]
    v_pk_mul_f32 v[74:75], v[74:75], v[174:175]
    v_permlane16_swap_b32 v152, v153
    v_mov_b64 v[154:155], v[152:153]
    v_pk_fma_f32 v[100:101], v[176:177], v[232:233], v[100:101] op_sel:[0,1,0]
    v_pk_fma_f32 v[102:103], v[178:179], v[232:233], v[102:103] op_sel:[0,1,0]
    v_permlane32_swap_b32 v152, v154
    v_permlane32_swap_b32 v153, v155
    v_pk_mul_f32 v[146:147], v[146:147], v[152:153] op_sel:[0,1]
    v_pk_mul_f32 v[148:149], v[148:149], v[154:155] op_sel_hi:[1,0]
    v_cvt_pk_bf16_f32 v146, v146, v146
    v_cvt_pk_bf16_f32 v147, v147, v147
    v_pk_mul_f32 v[52:53], v[52:53], v[164:165]
    v_pk_mul_f32 v[54:55], v[54:55], v[166:167]
    v_pk_mul_f32 v[76:77], v[76:77], v[172:173]
    v_pk_mul_f32 v[78:79], v[78:79], v[174:175]
    v_pk_mul_f32 v[96:97], v[96:97], v[180:181]
    v_pk_mul_f32 v[98:99], v[98:99], v[182:183]
    v_cvt_pk_bf16_f32 v186, v48, v49
    v_cvt_pk_bf16_f32 v187, v50, v51
    v_cvt_pk_bf16_f32 v188, v72, v73
    v_cvt_pk_bf16_f32 v189, v74, v75
    v_and_b32 v60, v146, v248
    v_and_b32 v61, v147, v249
    v_and_b32 v62, v146, v250
    v_and_b32 v63, v147, v251
    v_pk_mul_f32 v[150:151], v[150:151], v[154:155] op_sel:[0,1]
    v_cvt_pk_bf16_f32 v148, v148, v148
    v_cvt_pk_bf16_f32 v149, v149, v149
    v_pk_mul_f32 v[100:101], v[100:101], v[180:181]
    v_pk_mul_f32 v[102:103], v[102:103], v[182:183]
    v_cvt_pk_bf16_f32 v198, v52, v53
    v_cvt_pk_bf16_f32 v199, v54, v55
    v_cvt_pk_bf16_f32 v200, v76, v77
    v_cvt_pk_bf16_f32 v201, v78, v79
    v_cvt_pk_bf16_f32 v190, v96, v97
    v_cvt_pk_bf16_f32 v191, v98, v99
    v_and_b32 v84, v148, v248
    v_and_b32 v85, v149, v249
    v_and_b32 v86, v148, v250
    v_and_b32 v87, v149, v251
    v_cvt_pk_bf16_f32 v150, v150, v150
    v_cvt_pk_bf16_f32 v151, v151, v151
    v_mfma_f32_16x16x32_bf16 v[72:75], v[186:189], v[60:63], 0
    v_cvt_pk_bf16_f32 v202, v100, v101
    v_cvt_pk_bf16_f32 v203, v102, v103
    v_and_b32 v108, v150, v248
    v_and_b32 v109, v151, v249
    v_and_b32 v110, v150, v250
    v_and_b32 v111, v151, v251
    v_mfma_f32_16x16x32_bf16 v[76:79], v[198:201], v[60:63], 0
    v_mov_b32 v212, 0x3f803f80
    v_mov_b32 v213, 0x3f803f80
    v_mfma_f32_16x16x32_bf16 v[96:99], v[188:191], v[84:87], 0
    v_cvt_pk_bf16_f32 v72, v72, v73
    v_cvt_pk_bf16_f32 v73, v74, v75
    v_mfma_f32_16x16x32_bf16 v[100:103], v[200:203], v[84:87], 0
    v_mov_b32 v214, 0x3f803f80
    v_mov_b32 v215, 0x3f803f80
    v_mfma_f32_16x16x32_bf16 v[120:123], v[190:193], v[108:111], 0
    v_cvt_pk_bf16_f32 v74, v76, v77
    v_cvt_pk_bf16_f32 v75, v78, v79
    v_mfma_f32_16x16x32_bf16 v[124:127], v[202:205], v[108:111], 0
    v_cvt_pk_bf16_f32 v96, v96, v97
    v_cvt_pk_bf16_f32 v97, v98, v99
    buffer_store_dwordx4 v[72:75], v2, s[24:27], s83 offen sc1
    v_cvt_pk_bf16_f32 v98, v100, v101
    v_cvt_pk_bf16_f32 v99, v102, v103
    v_cvt_pk_bf16_f32 v120, v120, v121
    v_cvt_pk_bf16_f32 v121, v122, v123
    buffer_store_dwordx4 v[96:99], v2, s[24:27], s82 offen sc1
    v_cvt_pk_bf16_f32 v122, v124, v125
    v_cvt_pk_bf16_f32 v123, v126, v127
    buffer_store_dwordx4 v[120:123], v2, s[24:27], s81 offen sc1
    v_pk_fma_f32 v[32:33], v[128:129], v[216:217], v[32:33] op_sel_hi:[1,0,1]
    v_pk_fma_f32 v[34:35], v[130:131], v[216:217], v[34:35] op_sel_hi:[1,0,1]
    v_pk_fma_f32 v[36:37], v[132:133], v[216:217], v[36:37] op_sel_hi:[1,0,1]
    v_pk_fma_f32 v[38:39], v[134:135], v[216:217], v[38:39] op_sel_hi:[1,0,1]
    v_cvt_pk_bf16_f32 v32, v32, v33
    v_cvt_pk_bf16_f32 v33, v34, v35
    v_cvt_pk_bf16_f32 v34, v36, v37
    v_cvt_pk_bf16_f32 v35, v38, v39
    s_nop 1
    v_mfma_f32_16x16x32_bf16 v[208:211], v[40:43], v[32:35], v[240:243]
    s_cmp_eq_u32 s65, 0
    s_cbranch_scc0 L_hu_10
    s_mov_b32 s60, 0
    s_branch L_chk_13
L_spin_12:
    buffer_load_dwordx4 v[136:139], v2, s[24:27], s80 offen offset:0 sc1
    buffer_load_dwordx4 v[140:143], v2, s[24:27], s80 offen offset:1024 sc1
    s_add_u32 s60, s60, 1
    s_cmp_lt_u32 s60, 300000
    s_cbranch_scc0 L_tmo_14
    s_waitcnt vmcnt(0)
L_chk_13:
    s_waitcnt vmcnt(3)
    v_mfma_f32_16x16x32_bf16 v[36:39], v[136:139], v[32:35], v[244:247]
    v_max_u32 v156, v136, v137
    v_max3_u32 v156, v156, v138, v139
    v_max_u32 v157, v140, v141
    v_max3_u32 v157, v157, v142, v143
    v_max_u32 v156, v156, v157
    v_cmp_eq_u32 vcc, -1, v156
    s_cbranch_vccnz L_spin_12
L_done_16:
L_hv_11:
    s_nop 0
    s_nop 3
    v_max3_f32 v144, v36, v37, v208
    v_max3_f32 v145, v38, v39, v210
    v_max_f32 v144, v144, v209
    v_max_f32 v145, v145, v211
    v_mul_f32 v144, v220, v144
    v_mul_f32 v145, v220, v145
    v_max_f32 v152, v144, v145
    v_mov_b32 v153, v152
    v_mov_b64 v[184:185], v[140:141]
    v_mov_b64 v[196:197], v[142:143]
    v_permlane32_swap_b32 v152, v153
    v_max_f32 v152, v152, v153
    v_mov_b32 v153, v152
    s_nop 1
    v_permlane16_swap_b32 v152, v153
    v_max_f32 v152, v152, v153
    v_sub_f32 v144, v144, v152
    v_sub_f32 v145, v145, v152
    v_exp_f32 v144, v144
    v_exp_f32 v145, v145
    v_cvt_pk_bf16_f32 v144, v144, v144
    v_and_b32 v36, v144, v248
    v_cvt_pk_bf16_f32 v145, v145, v145
    v_and_b32 v37, v145, v249
    v_and_b32 v38, v144, v250
    v_and_b32 v39, v145, v251
    s_nop 1
    v_mfma_f32_16x16x32_bf16 v[224:227], v[212:215], v[36:39], 0
    v_mfma_f32_16x16x32_bf16 v[48:51], v[184:187], v[36:39], 0
    v_mfma_f32_16x16x32_bf16 v[52:55], v[196:199], v[36:39], 0
    s_nop 5
    v_rcp_f32 v224, v224
    s_nop 0
    v_pk_mul_f32 v[48:49], v[48:49], v[224:225] op_sel_hi:[1,0]
    v_pk_mul_f32 v[50:51], v[50:51], v[224:225] op_sel_hi:[1,0]
    v_cvt_pk_bf16_f32 v48, v48, v49
    v_cvt_pk_bf16_f32 v49, v50, v51
    v_pk_mul_f32 v[52:53], v[52:53], v[224:225] op_sel_hi:[1,0]
    v_pk_mul_f32 v[54:55], v[54:55], v[224:225] op_sel_hi:[1,0]
    v_cvt_pk_bf16_f32 v50, v52, v53
    v_cvt_pk_bf16_f32 v51, v54, v55
    buffer_store_dwordx4 v[48:51], v2, s[24:27], s79 offen sc1
L_ophase:
    v_mov_b32 v197, 158464
    ds_read_b32 v197, v197
    v_permlane16_swap_b32 v16, v18
    v_permlane16_swap_b32 v17, v19
    v_permlane16_swap_b32 v20, v22
    v_permlane16_swap_b32 v21, v23
    v_permlane16_swap_b32 v24, v26
    v_permlane16_swap_b32 v25, v27
    v_permlane16_swap_b32 v28, v30
    v_permlane16_swap_b32 v29, v31
    s_waitcnt lgkmcnt(0)
    v_readfirstlane_b32 s3, v197
    s_xor_b32 s52, s84, 128
    s_lshl_b32 s83, s52, 5
    s_add_u32 s83, s83, 0x700000
    v_bfe_u32 v204, v1, 1, 3
    v_and_b32 v198, 1, v1
    v_lshl_add_u32 v204, v204, 2, v198
    v_lshlrev_b32 v204, 7, v204
    v_bfe_u32 v196, v1, 1, 3
    v_and_b32 v198, 1, v1
    v_lshl_add_u32 v196, v196, 2, v198
    s_cmp_eq_u32 s3, 1
    s_cselect_b32 s52, 0, 5
    s_cselect_b32 s53, 0, 7340032
    s_lshl_b32 s84, s84, s52
    s_add_u32 s84, s84, s53
    s_add_u32 s52, s52, 2
    v_lshlrev_b32 v196, s52, v196
    s_cmp_eq_u32 s3, 1
    s_cselect_b32 s82, s84, 1073741824
    v_lshlrev_b32 v128, 16, v16
    v_and_b32 v129, 0xffff0000, v16
    v_lshlrev_b32 v130, 16, v17
    v_and_b32 v131, 0xffff0000, v17
    v_lshlrev_b32 v132, 16, v18
    v_and_b32 v133, 0xffff0000, v18
    v_lshlrev_b32 v134, 16, v19
    v_and_b32 v135, 0xffff0000, v19
    v_lshlrev_b32 v136, 16, v20
    v_and_b32 v137, 0xffff0000, v20
    v_lshlrev_b32 v138, 16, v21
    v_and_b32 v139, 0xffff0000, v21
    v_lshlrev_b32 v140, 16, v22
    v_and_b32 v141, 0xffff0000, v22
    v_lshlrev_b32 v142, 16, v23
    v_and_b32 v143, 0xffff0000, v23
    v_lshlrev_b32 v144, 16, v24
    v_and_b32 v145, 0xffff0000, v24
    v_lshlrev_b32 v146, 16, v25
    v_and_b32 v147, 0xffff0000, v25
    v_lshlrev_b32 v148, 16, v26
    v_and_b32 v149, 0xffff0000, v26
    v_lshlrev_b32 v150, 16, v27
    v_and_b32 v151, 0xffff0000, v27
    v_lshlrev_b32 v152, 16, v28
    v_and_b32 v153, 0xffff0000, v28
    v_lshlrev_b32 v154, 16, v29
    v_and_b32 v155, 0xffff0000, v29
    v_lshlrev_b32 v156, 16, v30
    v_and_b32 v157, 0xffff0000, v30
    v_lshlrev_b32 v158, 16, v31
    v_and_b32 v159, 0xffff0000, v31
    s_waitcnt vmcnt(0)
    s_mov_b64 exec, 1
    buffer_store_dword v0, off, s[24:27], s86
    s_mov_b64 exec, -1
    buffer_load_dword v197, v196, s[24:27], s82 offen nt
    s_mov_b64 exec, 1
    buffer_store_dword v0, off, s[24:27], s87 sc1
    s_mov_b64 exec, -1
    v_lshrrev_b32 v199, 4, v1
    v_bfe_u32 v206, v1, 2, 2
    v_lshl_add_u32 v198, v199, 3, v206
    v_lshrrev_b32 v206, 1, v206
    v_and_b32 v199, 1, v199
    v_lshl_add_u32 v206, v199, 1, v206
    v_and_b32 v199, 3, v1
    v_lshlrev_b32 v199, 3, v199
    v_lshl_add_u32 v199, v198, 7, v199
    v_add_u32 v199, 24576, v199
    v_xor_b32 v198, 0, v206
    v_lshl_add_u32 v192, v198, 5, v199
    v_xor_b32 v198, 1, v206
    v_lshl_add_u32 v193, v198, 5, v199
    v_xor_b32 v198, 2, v206
    v_lshl_add_u32 v194, v198, 5, v199
    v_xor_b32 v198, 3, v206
    v_lshl_add_u32 v195, v198, 5, v199
    s_barrier
    ds_read_b64_tr_b16 v[160:161], v192 offset:0
    ds_read_b64_tr_b16 v[162:163], v192 offset:512
    ds_read_b64_tr_b16 v[164:165], v193 offset:0
    ds_read_b64_tr_b16 v[166:167], v193 offset:512
    ds_read_b64_tr_b16 v[168:169], v194 offset:0
    ds_read_b64_tr_b16 v[170:171], v194 offset:512
    ds_read_b64_tr_b16 v[172:173], v195 offset:0
    ds_read_b64_tr_b16 v[174:175], v195 offset:512
    s_mov_b32 s60, 0
    s_cmp_eq_u32 s3, 1
    s_cbranch_scc0 L_alt_25
    s_branch L_chk_23
L_spin_22:
    buffer_load_dword v197, v196, s[24:27], s84 offen nt
    s_add_u32 s60, s60, 1
    s_cmp_lt_u32 s60, 300000
    s_cbranch_scc0 L_tmo_24
    s_waitcnt vmcnt(0)
L_chk_23:
    s_waitcnt vmcnt(1) lgkmcnt(0)
    v_cmp_eq_u32 vcc, 0, v197
    s_cbranch_vccnz L_spin_22
L_done_26:
    buffer_load_dwordx4 v[32:35], v2, s[24:27], s75 offen offset:0 sc1
    buffer_load_dwordx4 v[36:39], v2, s[24:27], s76 offen offset:0 sc1
    buffer_load_dwordx4 v[40:43], v2, s[24:27], s75 offen offset:1024 sc1
    buffer_load_dwordx4 v[44:47], v2, s[24:27], s76 offen offset:1024 sc1
    buffer_load_dwordx4 v[48:51], v2, s[24:27], s75 offen offset:2048 sc1
    buffer_load_dwordx4 v[52:55], v2, s[24:27], s76 offen offset:2048 sc1
    buffer_load_dwordx4 v[56:59], v2, s[24:27], s75 offen offset:3072 sc1
    s_add_u32 s78, s78, 4096
    s_and_b32 s78, s78, 0x7fff
    s_add_u32 s75, s77, s78
    buffer_load_dwordx4 v[60:63], v2, s[24:27], s76 offen offset:3072 sc1
    s_add_u32 s76, s75, 32768
    buffer_load_dwordx4 v[64:67], v2, s[24:27], s75 offen offset:0 sc1
    buffer_load_dwordx4 v[68:71], v2, s[24:27], s76 offen offset:0 sc1
    buffer_load_dwordx4 v[72:75], v2, s[24:27], s75 offen offset:1024 sc1
    buffer_load_dwordx4 v[76:79], v2, s[24:27], s76 offen offset:1024 sc1
    s_cmp_eq_u32 s66, 0
    s_cselect_b64 vcc, -1, 0
    v_cndmask_b32 v12, v194, v192, vcc
    v_cndmask_b32 v13, v195, v193, vcc
    v_subrev_u32 v12, 24576, v12
    v_subrev_u32 v13, 24576, v13
    s_lshl_b32 s52, s65, 13
    s_add_u32 s52, s52, 0x6000
    v_add_u32 v10, s52, v2
    v_add_u32 v11, 1024, v10
    s_lshl_b32 s52, s50, 12
    s_add_u32 s52, s52, 0x6000
    v_add_u32 v206, s52, v4
    s_bitcmp1_b32 s51, 0
    s_cbranch_scc1 L_nextA
    v_and_b32 v208, 15, v1
    v_lshrrev_b32 v209, 4, v1
    v_lshlrev_b32 v209, 2, v209
    v_sub_u32 v208, v208, v209
    v_mov_b32 v210, 0xf149f2ca
    v_add_u32 v209, 16, v208
    v_and_b32 v209, -15, v209
    v_cmp_eq_u32 vcc, 0, v209
    s_nop 1
    v_cndmask_b32 v236, v210, 0, vcc
    v_cndmask_b32 v248, 0, -1, vcc
    v_lshrrev_b32 v248, 16, v248
    v_add_u32 v209, 15, v208
    v_and_b32 v209, -15, v209
    v_cmp_eq_u32 vcc, 0, v209
    s_nop 1
    v_cndmask_b32 v237, v210, 0, vcc
    v_cndmask_b32 v209, 0, -1, vcc
    v_lshl_or_b32 v248, v209, 16, v248
    v_add_u32 v209, 14, v208
    v_and_b32 v209, -15, v209
    v_cmp_eq_u32 vcc, 0, v209
    s_nop 1
    v_cndmask_b32 v238, v210, 0, vcc
    v_cndmask_b32 v249, 0, -1, vcc
    v_lshrrev_b32 v249, 16, v249
    v_add_u32 v209, 13, v208
    v_and_b32 v209, -15, v209
    v_cmp_eq_u32 vcc, 0, v209
    s_nop 1
    v_cndmask_b32 v239, v210, 0, vcc
    v_cndmask_b32 v209, 0, -1, vcc
    v_lshl_or_b32 v249, v209, 16, v249
    v_add_u32 v209, 0, v208
    v_and_b32 v209, -15, v209
    v_cmp_eq_u32 vcc, 0, v209
    s_nop 1
    v_cndmask_b32 v240, v210, 0, vcc
    v_cndmask_b32 v250, 0, -1, vcc
    v_lshrrev_b32 v250, 16, v250
    v_add_u32 v209, -1, v208
    v_and_b32 v209, -15, v209
    v_cmp_eq_u32 vcc, 0, v209
    s_nop 1
    v_cndmask_b32 v241, v210, 0, vcc
    v_cndmask_b32 v209, 0, -1, vcc
    v_lshl_or_b32 v250, v209, 16, v250
    v_add_u32 v209, -2, v208
    v_and_b32 v209, -15, v209
    v_cmp_eq_u32 vcc, 0, v209
    s_nop 1
    v_cndmask_b32 v242, v210, 0, vcc
    v_cndmask_b32 v251, 0, -1, vcc
    v_lshrrev_b32 v251, 16, v251
    v_add_u32 v209, -3, v208
    v_and_b32 v209, -15, v209
    v_cmp_eq_u32 vcc, 0, v209
    s_nop 1
    v_cndmask_b32 v243, v210, 0, vcc
    v_cndmask_b32 v209, 0, -1, vcc
    v_lshl_or_b32 v251, v209, 16, v251
    s_or_b32 s52, s48, s65
    s_cselect_b64 vcc, -1, 0
    v_cndmask_b32 v244, v210, v236, vcc
    v_cndmask_b32 v245, v210, v237, vcc
    v_cndmask_b32 v246, v210, v238, vcc
    v_cndmask_b32 v247, v210, v239, vcc
    s_lshl_b32 s52, s66, 11
    s_add_u32 s52, s52, 0x26c00
    v_add_u32 v252, s52, v2
    s_add_u32 s53, s52, 1024
    s_cmp_eq_u32 s65, 0
    s_cselect_b32 s52, s52, 162816
    s_cselect_b32 s53, s53, 162816
    v_add_u32 v253, s52, v2
    v_add_u32 v254, s53, v2
    s_branch L_next_done
L_nextA:
    s_cmp_lg_u32 s51, 3
    s_cbranch_scc0 L_skip_28
    v_lshrrev_b32 v208, 5, v1
    v_bfe_u32 v209, v1, 2, 2
    v_lshl_add_u32 v209, v208, 3, v209
    v_bfe_u32 v210, v1, 4, 1
    v_and_b32 v211, 3, v1
    v_lshlrev_b32 v212, 3, v211
    v_lshl_add_u32 v210, v210, 5, v212
    s_lshl_b32 s52, s66, 11
    s_add_u32 s52, s52, 0x26c00
    v_lshl_add_u32 v212, v209, 6, v210
    v_add_u32 v248, s52, v212
    s_mul_i32 s54, s50, 5120
    v_mul_u32_u24 v209, 136, v209
    v_add3_u32 v209, v209, v210, s54
    s_lshl_b32 s53, s65, 6
    v_add_u32 v250, s53, v209
    s_xor_b32 s55, s53, 64
    v_add_u32 v251, s55, v209
    v_and_b32 v212, 31, v1
    v_mul_u32_u24 v212, 136, v212
    v_lshl_add_u32 v212, v208, 3, v212
    v_add_u32 v249, s54, v212
    v_add_u32 v253, s54, v2
    s_xor_b32 s52, s50, 2
    s_mul_i32 s52, s52, 5120
    v_add_u32 v254, s52, v2
    v_lshrrev_b32 v212, 4, v1
    v_xor_b32 v212, v212, v1
    v_and_b32 v212, 1, v212
    v_cmp_eq_u32 vcc, 0, v212
    v_mov_b32 v212, 0x3f803f80
    s_nop 0
    v_cndmask_b32 v240, 0, v212, vcc
    v_mov_b32 v241, v240
    v_mov_b64 v[242:243], v[240:241]
    v_and_b32 v208, 18, v1
    v_lshlrev_b32 v208, 1, v208
    v_and_or_b32 v208, v1, 8, v208
    v_and_b32 v209, 4, v1
    v_lshl_or_b32 v208, v209, 2, v208
    v_and_b32 v209, 33, v1
    v_lshl_or_b32 v252, v209, 25, v208
    v_lshl_or_b32 v252, v209, 30, v252
L_skip_28:
L_next_done:
    s_waitcnt vmcnt(11)
    v_mfma_f32_16x16x32_bf16 v[128:131], v[160:163], v[32:35], v[128:131]
    ds_read_b64_tr_b16 v[176:177], v192 offset:4096
    s_waitcnt vmcnt(10)
    v_mfma_f32_16x16x32_bf16 v[144:147], v[160:163], v[36:39], v[144:147]
    ds_read_b64_tr_b16 v[178:179], v192 offset:4608
    buffer_load_dwordx4 v[80:83], v2, s[24:27], s75 offen offset:2048 sc1
    v_mfma_f32_16x16x32_bf16 v[132:135], v[164:167], v[32:35], v[132:135]
    ds_read_b64_tr_b16 v[180:181], v193 offset:4096
    v_mfma_f32_16x16x32_bf16 v[148:151], v[164:167], v[36:39], v[148:151]
    ds_read_b64_tr_b16 v[182:183], v193 offset:4608
    v_mfma_f32_16x16x32_bf16 v[136:139], v[168:171], v[32:35], v[136:139]
    ds_read_b64_tr_b16 v[184:185], v194 offset:4096
    v_mfma_f32_16x16x32_bf16 v[152:155], v[168:171], v[36:39], v[152:155]
    ds_read_b64_tr_b16 v[186:187], v194 offset:4608
    buffer_load_dwordx4 v[84:87], v2, s[24:27], s76 offen offset:2048 sc1
    v_mfma_f32_16x16x32_bf16 v[140:143], v[172:175], v[32:35], v[140:143]
    ds_read_b64_tr_b16 v[188:189], v195 offset:4096
    v_mfma_f32_16x16x32_bf16 v[156:159], v[172:175], v[36:39], v[156:159]
    ds_read_b64_tr_b16 v[190:191], v195 offset:4608
    s_waitcnt vmcnt(11) lgkmcnt(6)
    v_mfma_f32_16x16x32_bf16 v[128:131], v[176:179], v[40:43], v[128:131]
    ds_read_b64_tr_b16 v[160:161], v192 offset:8192
    s_waitcnt vmcnt(10)
    v_mfma_f32_16x16x32_bf16 v[144:147], v[176:179], v[44:47], v[144:147]
    ds_read_b64_tr_b16 v[162:163], v192 offset:8704
    buffer_load_dwordx4 v[32:35], v2, s[24:27], s75 offen offset:3072 sc1
    s_add_u32 s78, s78, 4096
    s_and_b32 s78, s78, 0x7fff
    s_add_u32 s75, s77, s78
    s_waitcnt lgkmcnt(6)
    v_mfma_f32_16x16x32_bf16 v[132:135], v[180:183], v[40:43], v[132:135]
    ds_read_b64_tr_b16 v[164:165], v193 offset:8192
    v_mfma_f32_16x16x32_bf16 v[148:151], v[180:183], v[44:47], v[148:151]
    ds_read_b64_tr_b16 v[166:167], v193 offset:8704
    s_waitcnt lgkmcnt(6)
    v_mfma_f32_16x16x32_bf16 v[136:139], v[184:187], v[40:43], v[136:139]
    ds_read_b64_tr_b16 v[168:169], v194 offset:8192
    v_mfma_f32_16x16x32_bf16 v[152:155], v[184:187], v[44:47], v[152:155]
    ds_read_b64_tr_b16 v[170:171], v194 offset:8704
    buffer_load_dwordx4 v[36:39], v2, s[24:27], s76 offen offset:3072 sc1
    s_add_u32 s76, s75, 32768
    s_waitcnt lgkmcnt(6)
    v_mfma_f32_16x16x32_bf16 v[140:143], v[188:191], v[40:43], v[140:143]
    ds_read_b64_tr_b16 v[172:173], v195 offset:8192
    v_mfma_f32_16x16x32_bf16 v[156:159], v[188:191], v[44:47], v[156:159]
    ds_read_b64_tr_b16 v[174:175], v195 offset:8704
    s_waitcnt vmcnt(11) lgkmcnt(6)
    v_mfma_f32_16x16x32_bf16 v[128:131], v[160:163], v[48:51], v[128:131]
    ds_read_b64_tr_b16 v[176:177], v192 offset:12288
    s_waitcnt vmcnt(10)
    v_mfma_f32_16x16x32_bf16 v[144:147], v[160:163], v[52:55], v[144:147]
    ds_read_b64_tr_b16 v[178:179], v192 offset:12800
    buffer_load_dwordx4 v[40:43], v2, s[24:27], s75 offen offset:0 sc1
    s_waitcnt lgkmcnt(6)
    v_mfma_f32_16x16x32_bf16 v[132:135], v[164:167], v[48:51], v[132:135]
    ds_read_b64_tr_b16 v[180:181], v193 offset:12288
    v_mfma_f32_16x16x32_bf16 v[148:151], v[164:167], v[52:55], v[148:151]
    ds_read_b64_tr_b16 v[182:183], v193 offset:12800
    s_waitcnt lgkmcnt(6)
    v_mfma_f32_16x16x32_bf16 v[136:139], v[168:171], v[48:51], v[136:139]
    ds_read_b64_tr_b16 v[184:185], v194 offset:12288
    v_mfma_f32_16x16x32_bf16 v[152:155], v[168:171], v[52:55], v[152:155]
    ds_read_b64_tr_b16 v[186:187], v194 offset:12800
    buffer_load_dwordx4 v[44:47], v2, s[24:27], s76 offen offset:0 sc1
    s_waitcnt lgkmcnt(6)
    v_mfma_f32_16x16x32_bf16 v[140:143], v[172:175], v[48:51], v[140:143]
    ds_read_b64_tr_b16 v[188:189], v195 offset:12288
    v_mfma_f32_16x16x32_bf16 v[156:159], v[172:175], v[52:55], v[156:159]
    ds_read_b64_tr_b16 v[190:191], v195 offset:12800
    s_waitcnt vmcnt(11) lgkmcnt(6)
    v_mfma_f32_16x16x32_bf16 v[128:131], v[176:179], v[56:59], v[128:131]
    ds_read_b64_tr_b16 v[160:161], v192 offset:16384
    s_waitcnt vmcnt(10)
    v_mfma_f32_16x16x32_bf16 v[144:147], v[176:179], v[60:63], v[144:147]
    ds_read_b64_tr_b16 v[162:163], v192 offset:16896
    buffer_load_dwordx4 v[48:51], v2, s[24:27], s75 offen offset:1024 sc1
    s_waitcnt lgkmcnt(6)
    v_mfma_f32_16x16x32_bf16 v[132:135], v[180:183], v[56:59], v[132:135]
    ds_read_b64_tr_b16 v[164:165], v193 offset:16384
    v_mfma_f32_16x16x32_bf16 v[148:151], v[180:183], v[60:63], v[148:151]
    ds_read_b64_tr_b16 v[166:167], v193 offset:16896
    s_waitcnt lgkmcnt(6)
    v_mfma_f32_16x16x32_bf16 v[136:139], v[184:187], v[56:59], v[136:139]
    ds_read_b64_tr_b16 v[168:169], v194 offset:16384
    v_mfma_f32_16x16x32_bf16 v[152:155], v[184:187], v[60:63], v[152:155]
    ds_read_b64_tr_b16 v[170:171], v194 offset:16896
    buffer_load_dwordx4 v[52:55], v2, s[24:27], s76 offen offset:1024 sc1
    s_waitcnt lgkmcnt(6)
    v_mfma_f32_16x16x32_bf16 v[140:143], v[188:191], v[56:59], v[140:143]
    ds_read_b64_tr_b16 v[172:173], v195 offset:16384
    v_mfma_f32_16x16x32_bf16 v[156:159], v[188:191], v[60:63], v[156:159]
    ds_read_b64_tr_b16 v[174:175], v195 offset:16896
    s_waitcnt vmcnt(11) lgkmcnt(6)
    v_mfma_f32_16x16x32_bf16 v[128:131], v[160:163], v[64:67], v[128:131]
    ds_read_b64_tr_b16 v[176:177], v192 offset:20480
    s_waitcnt vmcnt(10)
    v_mfma_f32_16x16x32_bf16 v[144:147], v[160:163], v[68:71], v[144:147]
    ds_read_b64_tr_b16 v[178:179], v192 offset:20992
    buffer_load_dwordx4 v[56:59], v2, s[24:27], s75 offen offset:2048 sc1
    s_waitcnt lgkmcnt(6)
    v_mfma_f32_16x16x32_bf16 v[132:135], v[164:167], v[64:67], v[132:135]
    ds_read_b64_tr_b16 v[180:181], v193 offset:20480
    v_mfma_f32_16x16x32_bf16 v[148:151], v[164:167], v[68:71], v[148:151]
    ds_read_b64_tr_b16 v[182:183], v193 offset:20992
    s_waitcnt lgkmcnt(6)
    v_mfma_f32_16x16x32_bf16 v[136:139], v[168:171], v[64:67], v[136:139]
    ds_read_b64_tr_b16 v[184:185], v194 offset:20480
    v_mfma_f32_16x16x32_bf16 v[152:155], v[168:171], v[68:71], v[152:155]
    ds_read_b64_tr_b16 v[186:187], v194 offset:20992
    buffer_load_dwordx4 v[60:63], v2, s[24:27], s76 offen offset:2048 sc1
    s_waitcnt lgkmcnt(6)
    v_mfma_f32_16x16x32_bf16 v[140:143], v[172:175], v[64:67], v[140:143]
    ds_read_b64_tr_b16 v[188:189], v195 offset:20480
    v_mfma_f32_16x16x32_bf16 v[156:159], v[172:175], v[68:71], v[156:159]
    ds_read_b64_tr_b16 v[190:191], v195 offset:20992
    buffer_load_dword v198, v204, s[24:27], s83 offen sc1
    s_waitcnt vmcnt(12) lgkmcnt(6)
    v_mfma_f32_16x16x32_bf16 v[128:131], v[176:179], v[72:75], v[128:131]
    ds_read_b64_tr_b16 v[160:161], v192 offset:24576
    s_waitcnt vmcnt(11)
    v_mfma_f32_16x16x32_bf16 v[144:147], v[176:179], v[76:79], v[144:147]
    ds_read_b64_tr_b16 v[162:163], v192 offset:25088
    buffer_load_dwordx4 v[64:67], v2, s[24:27], s75 offen offset:3072 sc1
    s_add_u32 s78, s78, 4096
    s_and_b32 s78, s78, 0x7fff
    s_add_u32 s75, s77, s78
    s_waitcnt lgkmcnt(6)
    v_mfma_f32_16x16x32_bf16 v[132:135], v[180:183], v[72:75], v[132:135]
    ds_read_b64_tr_b16 v[164:165], v193 offset:24576
    v_mfma_f32_16x16x32_bf16 v[148:151], v[180:183], v[76:79], v[148:151]
    ds_read_b64_tr_b16 v[166:167], v193 offset:25088
    s_waitcnt lgkmcnt(6)
    v_mfma_f32_16x16x32_bf16 v[136:139], v[184:187], v[72:75], v[136:139]
    ds_read_b64_tr_b16 v[168:169], v194 offset:24576
    v_mfma_f32_16x16x32_bf16 v[152:155], v[184:187], v[76:79], v[152:155]
    ds_read_b64_tr_b16 v[170:171], v194 offset:25088
    buffer_load_dwordx4 v[68:71], v2, s[24:27], s76 offen offset:3072 sc1
    s_add_u32 s76, s75, 32768
    s_waitcnt lgkmcnt(6)
    v_mfma_f32_16x16x32_bf16 v[140:143], v[188:191], v[72:75], v[140:143]
    ds_read_b64_tr_b16 v[172:173], v195 offset:24576
    v_mfma_f32_16x16x32_bf16 v[156:159], v[188:191], v[76:79], v[156:159]
    ds_read_b64_tr_b16 v[174:175], v195 offset:25088
    s_waitcnt vmcnt(12) lgkmcnt(6)
    v_mfma_f32_16x16x32_bf16 v[128:131], v[160:163], v[80:83], v[128:131]
    ds_read_b64_tr_b16 v[176:177], v192 offset:28672
    s_waitcnt vmcnt(11)
    v_mfma_f32_16x16x32_bf16 v[144:147], v[160:163], v[84:87], v[144:147]
    ds_read_b64_tr_b16 v[178:179], v192 offset:29184
    buffer_load_dwordx4 v[72:75], v2, s[24:27], s75 offen offset:0 sc1
    s_waitcnt lgkmcnt(6)
    v_mfma_f32_16x16x32_bf16 v[132:135], v[164:167], v[80:83], v[132:135]
    ds_read_b64_tr_b16 v[180:181], v193 offset:28672
    v_mfma_f32_16x16x32_bf16 v[148:151], v[164:167], v[84:87], v[148:151]
    ds_read_b64_tr_b16 v[182:183], v193 offset:29184
    s_waitcnt lgkmcnt(6)
    v_mfma_f32_16x16x32_bf16 v[136:139], v[168:171], v[80:83], v[136:139]
    ds_read_b64_tr_b16 v[184:185], v194 offset:28672
    v_mfma_f32_16x16x32_bf16 v[152:155], v[168:171], v[84:87], v[152:155]
    ds_read_b64_tr_b16 v[186:187], v194 offset:29184
    buffer_load_dwordx4 v[76:79], v2, s[24:27], s76 offen offset:0 sc1
    s_waitcnt lgkmcnt(6)
    v_mfma_f32_16x16x32_bf16 v[140:143], v[172:175], v[80:83], v[140:143]
    ds_read_b64_tr_b16 v[188:189], v195 offset:28672
    v_mfma_f32_16x16x32_bf16 v[156:159], v[172:175], v[84:87], v[156:159]
    ds_read_b64_tr_b16 v[190:191], v195 offset:29184
    s_waitcnt vmcnt(12) lgkmcnt(6)
    v_mfma_f32_16x16x32_bf16 v[128:131], v[176:179], v[32:35], v[128:131]
    ds_read_b64_tr_b16 v[160:161], v192 offset:32768
    s_waitcnt vmcnt(11)
    v_mfma_f32_16x16x32_bf16 v[144:147], v[176:179], v[36:39], v[144:147]
    ds_read_b64_tr_b16 v[162:163], v192 offset:33280
    buffer_load_dwordx4 v[80:83], v2, s[24:27], s75 offen offset:1024 sc1
    s_waitcnt lgkmcnt(6)
    v_mfma_f32_16x16x32_bf16 v[132:135], v[180:183], v[32:35], v[132:135]
    ds_read_b64_tr_b16 v[164:165], v193 offset:32768
    v_mfma_f32_16x16x32_bf16 v[148:151], v[180:183], v[36:39], v[148:151]
    ds_read_b64_tr_b16 v[166:167], v193 offset:33280
    s_waitcnt lgkmcnt(6)
    v_mfma_f32_16x16x32_bf16 v[136:139], v[184:187], v[32:35], v[136:139]
    ds_read_b64_tr_b16 v[168:169], v194 offset:32768
    v_mfma_f32_16x16x32_bf16 v[152:155], v[184:187], v[36:39], v[152:155]
    ds_read_b64_tr_b16 v[170:171], v194 offset:33280
    buffer_load_dwordx4 v[84:87], v2, s[24:27], s76 offen offset:1024 sc1
    s_waitcnt lgkmcnt(6)
    v_mfma_f32_16x16x32_bf16 v[140:143], v[188:191], v[32:35], v[140:143]
    ds_read_b64_tr_b16 v[172:173], v195 offset:32768
    v_mfma_f32_16x16x32_bf16 v[156:159], v[188:191], v[36:39], v[156:159]
    ds_read_b64_tr_b16 v[174:175], v195 offset:33280
    s_waitcnt vmcnt(12) lgkmcnt(6)
    v_mfma_f32_16x16x32_bf16 v[128:131], v[160:163], v[40:43], v[128:131]
    ds_read_b64_tr_b16 v[176:177], v192 offset:36864
    s_waitcnt vmcnt(11)
    v_mfma_f32_16x16x32_bf16 v[144:147], v[160:163], v[44:47], v[144:147]
    ds_read_b64_tr_b16 v[178:179], v192 offset:37376
    buffer_load_dwordx4 v[32:35], v2, s[24:27], s75 offen offset:2048 sc1
    s_waitcnt lgkmcnt(6)
    v_mfma_f32_16x16x32_bf16 v[132:135], v[164:167], v[40:43], v[132:135]
    ds_read_b64_tr_b16 v[180:181], v193 offset:36864
    v_mfma_f32_16x16x32_bf16 v[148:151], v[164:167], v[44:47], v[148:151]
    ds_read_b64_tr_b16 v[182:183], v193 offset:37376
    s_waitcnt lgkmcnt(6)
    v_mfma_f32_16x16x32_bf16 v[136:139], v[168:171], v[40:43], v[136:139]
    ds_read_b64_tr_b16 v[184:185], v194 offset:36864
    v_mfma_f32_16x16x32_bf16 v[152:155], v[168:171], v[44:47], v[152:155]
    ds_read_b64_tr_b16 v[186:187], v194 offset:37376
    buffer_load_dwordx4 v[36:39], v2, s[24:27], s76 offen offset:2048 sc1
    s_waitcnt lgkmcnt(6)
    v_mfma_f32_16x16x32_bf16 v[140:143], v[172:175], v[40:43], v[140:143]
    ds_read_b64_tr_b16 v[188:189], v195 offset:36864
    v_mfma_f32_16x16x32_bf16 v[156:159], v[172:175], v[44:47], v[156:159]
    ds_read_b64_tr_b16 v[190:191], v195 offset:37376
    s_waitcnt vmcnt(12) lgkmcnt(6)
    v_mfma_f32_16x16x32_bf16 v[128:131], v[176:179], v[48:51], v[128:131]
    ds_read_b64_tr_b16 v[160:161], v192 offset:40960
    s_waitcnt vmcnt(11)
    v_mfma_f32_16x16x32_bf16 v[144:147], v[176:179], v[52:55], v[144:147]
    ds_read_b64_tr_b16 v[162:163], v192 offset:41472
    buffer_load_dwordx4 v[40:43], v2, s[24:27], s75 offen offset:3072 sc1
    s_add_u32 s78, s78, 4096
    s_and_b32 s78, s78, 0x7fff
    s_add_u32 s75, s77, s78
    s_waitcnt lgkmcnt(6)
    v_mfma_f32_16x16x32_bf16 v[132:135], v[180:183], v[48:51], v[132:135]
    ds_read_b64_tr_b16 v[164:165], v193 offset:40960
    v_mfma_f32_16x16x32_bf16 v[148:151], v[180:183], v[52:55], v[148:151]
    ds_read_b64_tr_b16 v[166:167], v193 offset:41472
    s_waitcnt lgkmcnt(6)
    v_mfma_f32_16x16x32_bf16 v[136:139], v[184:187], v[48:51], v[136:139]
    ds_read_b64_tr_b16 v[168:169], v194 offset:40960
    v_mfma_f32_16x16x32_bf16 v[152:155], v[184:187], v[52:55], v[152:155]
    ds_read_b64_tr_b16 v[170:171], v194 offset:41472
    buffer_load_dwordx4 v[44:47], v2, s[24:27], s76 offen offset:3072 sc1
    s_add_u32 s76, s75, 32768
    s_waitcnt lgkmcnt(6)
    v_mfma_f32_16x16x32_bf16 v[140:143], v[188:191], v[48:51], v[140:143]
    ds_read_b64_tr_b16 v[172:173], v195 offset:40960
    v_mfma_f32_16x16x32_bf16 v[156:159], v[188:191], v[52:55], v[156:159]
    ds_read_b64_tr_b16 v[174:175], v195 offset:41472
    s_waitcnt vmcnt(10)
    v_cmp_eq_u32 vcc, 0, v198
    s_cbranch_vccnz L_alt_32
L_done_33:
    s_waitcnt lgkmcnt(6)
    v_mfma_f32_16x16x32_bf16 v[128:131], v[160:163], v[56:59], v[128:131]
    ds_read_b64_tr_b16 v[176:177], v192 offset:45056
    v_mfma_f32_16x16x32_bf16 v[144:147], v[160:163], v[60:63], v[144:147]
    ds_read_b64_tr_b16 v[178:179], v192 offset:45568
    buffer_load_dwordx4 v[48:51], v2, s[24:27], s75 offen offset:0 sc1
    s_waitcnt lgkmcnt(6)
    v_mfma_f32_16x16x32_bf16 v[132:135], v[164:167], v[56:59], v[132:135]
    ds_read_b64_tr_b16 v[180:181], v193 offset:45056
    v_mfma_f32_16x16x32_bf16 v[148:151], v[164:167], v[60:63], v[148:151]
    ds_read_b64_tr_b16 v[182:183], v193 offset:45568
    s_waitcnt lgkmcnt(6)
    v_mfma_f32_16x16x32_bf16 v[136:139], v[168:171], v[56:59], v[136:139]
    ds_read_b64_tr_b16 v[184:185], v194 offset:45056
    v_mfma_f32_16x16x32_bf16 v[152:155], v[168:171], v[60:63], v[152:155]
    ds_read_b64_tr_b16 v[186:187], v194 offset:45568
    buffer_load_dwordx4 v[52:55], v2, s[24:27], s76 offen offset:0 sc1
    s_waitcnt lgkmcnt(6)
    v_mfma_f32_16x16x32_bf16 v[140:143], v[172:175], v[56:59], v[140:143]
    ds_read_b64_tr_b16 v[188:189], v195 offset:45056
    v_mfma_f32_16x16x32_bf16 v[156:159], v[172:175], v[60:63], v[156:159]
    ds_read_b64_tr_b16 v[190:191], v195 offset:45568
    s_waitcnt vmcnt(11) lgkmcnt(6)
    v_mfma_f32_16x16x32_bf16 v[128:131], v[176:179], v[64:67], v[128:131]
    ds_read_b64_tr_b16 v[160:161], v192 offset:49152
    s_waitcnt vmcnt(10)
    v_mfma_f32_16x16x32_bf16 v[144:147], v[176:179], v[68:71], v[144:147]
    ds_read_b64_tr_b16 v[162:163], v192 offset:49664
    buffer_load_dwordx4 v[56:59], v2, s[24:27], s75 offen offset:1024 sc1
    s_waitcnt lgkmcnt(6)
    v_mfma_f32_16x16x32_bf16 v[132:135], v[180:183], v[64:67], v[132:135]
    ds_read_b64_tr_b16 v[164:165], v193 offset:49152
    v_mfma_f32_16x16x32_bf16 v[148:151], v[180:183], v[68:71], v[148:151]
    ds_read_b64_tr_b16 v[166:167], v193 offset:49664
    s_waitcnt lgkmcnt(6)
    v_mfma_f32_16x16x32_bf16 v[136:139], v[184:187], v[64:67], v[136:139]
    ds_read_b64_tr_b16 v[168:169], v194 offset:49152
    v_mfma_f32_16x16x32_bf16 v[152:155], v[184:187], v[68:71], v[152:155]
    ds_read_b64_tr_b16 v[170:171], v194 offset:49664
    buffer_load_dwordx4 v[60:63], v2, s[24:27], s76 offen offset:1024 sc1
    s_waitcnt lgkmcnt(6)
    v_mfma_f32_16x16x32_bf16 v[140:143], v[188:191], v[64:67], v[140:143]
    ds_read_b64_tr_b16 v[172:173], v195 offset:49152
    v_mfma_f32_16x16x32_bf16 v[156:159], v[188:191], v[68:71], v[156:159]
    ds_read_b64_tr_b16 v[174:175], v195 offset:49664
    s_waitcnt vmcnt(11) lgkmcnt(6)
    v_mfma_f32_16x16x32_bf16 v[128:131], v[160:163], v[72:75], v[128:131]
    ds_read_b64_tr_b16 v[176:177], v192 offset:53248
    s_waitcnt vmcnt(10)
    v_mfma_f32_16x16x32_bf16 v[144:147], v[160:163], v[76:79], v[144:147]
    ds_read_b64_tr_b16 v[178:179], v192 offset:53760
    buffer_load_dwordx4 v[64:67], v2, s[24:27], s75 offen offset:2048 sc1
    s_waitcnt lgkmcnt(6)
    v_mfma_f32_16x16x32_bf16 v[132:135], v[164:167], v[72:75], v[132:135]
    ds_read_b64_tr_b16 v[180:181], v193 offset:53248
    v_mfma_f32_16x16x32_bf16 v[148:151], v[164:167], v[76:79], v[148:151]
    ds_read_b64_tr_b16 v[182:183], v193 offset:53760
    s_waitcnt lgkmcnt(6)
    v_mfma_f32_16x16x32_bf16 v[136:139], v[168:171], v[72:75], v[136:139]
    ds_read_b64_tr_b16 v[184:185], v194 offset:53248
    v_mfma_f32_16x16x32_bf16 v[152:155], v[168:171], v[76:79], v[152:155]
    ds_read_b64_tr_b16 v[186:187], v194 offset:53760
    buffer_load_dwordx4 v[68:71], v2, s[24:27], s76 offen offset:2048 sc1
    s_waitcnt lgkmcnt(6)
    v_mfma_f32_16x16x32_bf16 v[140:143], v[172:175], v[72:75], v[140:143]
    ds_read_b64_tr_b16 v[188:189], v195 offset:53248
    v_mfma_f32_16x16x32_bf16 v[156:159], v[172:175], v[76:79], v[156:159]
    ds_read_b64_tr_b16 v[190:191], v195 offset:53760
    s_waitcnt vmcnt(11) lgkmcnt(6)
    v_mfma_f32_16x16x32_bf16 v[128:131], v[176:179], v[80:83], v[128:131]
    ds_read_b64_tr_b16 v[160:161], v192 offset:57344
    s_waitcnt vmcnt(10)
    v_mfma_f32_16x16x32_bf16 v[144:147], v[176:179], v[84:87], v[144:147]
    ds_read_b64_tr_b16 v[162:163], v192 offset:57856
    buffer_load_dwordx4 v[72:75], v2, s[24:27], s75 offen offset:3072 sc1
    s_add_u32 s78, s78, 4096
    s_and_b32 s78, s78, 0x7fff
    s_add_u32 s75, s77, s78
    s_waitcnt lgkmcnt(6)
    v_mfma_f32_16x16x32_bf16 v[132:135], v[180:183], v[80:83], v[132:135]
    ds_read_b64_tr_b16 v[164:165], v193 offset:57344
    v_mfma_f32_16x16x32_bf16 v[148:151], v[180:183], v[84:87], v[148:151]
    ds_read_b64_tr_b16 v[166:167], v193 offset:57856
    s_waitcnt lgkmcnt(6)
    v_mfma_f32_16x16x32_bf16 v[136:139], v[184:187], v[80:83], v[136:139]
    ds_read_b64_tr_b16 v[168:169], v194 offset:57344
    v_mfma_f32_16x16x32_bf16 v[152:155], v[184:187], v[84:87], v[152:155]
    ds_read_b64_tr_b16 v[170:171], v194 offset:57856
    buffer_load_dwordx4 v[76:79], v2, s[24:27], s76 offen offset:3072 sc1
    s_add_u32 s76, s75, 32768
    s_waitcnt lgkmcnt(6)
    v_mfma_f32_16x16x32_bf16 v[140:143], v[188:191], v[80:83], v[140:143]
    ds_read_b64_tr_b16 v[172:173], v195 offset:57344
    v_mfma_f32_16x16x32_bf16 v[156:159], v[188:191], v[84:87], v[156:159]
    ds_read_b64_tr_b16 v[174:175], v195 offset:57856
    s_waitcnt vmcnt(11) lgkmcnt(6)
    v_mfma_f32_16x16x32_bf16 v[128:131], v[160:163], v[32:35], v[128:131]
    ds_read_b64_tr_b16 v[176:177], v192 offset:61440
    s_waitcnt vmcnt(10)
    v_mfma_f32_16x16x32_bf16 v[144:147], v[160:163], v[36:39], v[144:147]
    ds_read_b64_tr_b16 v[178:179], v192 offset:61952
    buffer_load_dwordx4 v[80:83], v2, s[24:27], s75 offen offset:0 sc1
    s_waitcnt lgkmcnt(6)
    v_mfma_f32_16x16x32_bf16 v[132:135], v[164:167], v[32:35], v[132:135]
    ds_read_b64_tr_b16 v[180:181], v193 offset:61440
    v_mfma_f32_16x16x32_bf16 v[148:151], v[164:167], v[36:39], v[148:151]
    ds_read_b64_tr_b16 v[182:183], v193 offset:61952
    s_waitcnt lgkmcnt(6)
    v_mfma_f32_16x16x32_bf16 v[136:139], v[168:171], v[32:35], v[136:139]
    ds_read_b64_tr_b16 v[184:185], v194 offset:61440
    v_mfma_f32_16x16x32_bf16 v[152:155], v[168:171], v[36:39], v[152:155]
    ds_read_b64_tr_b16 v[186:187], v194 offset:61952
    buffer_load_dwordx4 v[84:87], v2, s[24:27], s76 offen offset:0 sc1
    s_waitcnt lgkmcnt(6)
    v_mfma_f32_16x16x32_bf16 v[140:143], v[172:175], v[32:35], v[140:143]
    ds_read_b64_tr_b16 v[188:189], v195 offset:61440
    v_mfma_f32_16x16x32_bf16 v[156:159], v[172:175], v[36:39], v[156:159]
    ds_read_b64_tr_b16 v[190:191], v195 offset:61952
    v_add_u32 v192, 0x10000, v192
    v_add_u32 v193, 0x10000, v193
    v_add_u32 v194, 0x10000, v194
    v_add_u32 v195, 0x10000, v195
    s_waitcnt vmcnt(11) lgkmcnt(6)
    v_mfma_f32_16x16x32_bf16 v[128:131], v[176:179], v[40:43], v[128:131]
    ds_read_b64_tr_b16 v[160:161], v192 offset:0
    s_waitcnt vmcnt(10)
    v_mfma_f32_16x16x32_bf16 v[144:147], v[176:179], v[44:47], v[144:147]
    ds_read_b64_tr_b16 v[162:163], v192 offset:512
    buffer_load_dwordx4 v[32:35], v2, s[24:27], s75 offen offset:1024 sc1
    s_waitcnt lgkmcnt(6)
    v_mfma_f32_16x16x32_bf16 v[132:135], v[180:183], v[40:43], v[132:135]
    ds_read_b64_tr_b16 v[164:165], v193 offset:0
    v_mfma_f32_16x16x32_bf16 v[148:151], v[180:183], v[44:47], v[148:151]
    ds_read_b64_tr_b16 v[166:167], v193 offset:512
    s_waitcnt lgkmcnt(6)
    v_mfma_f32_16x16x32_bf16 v[136:139], v[184:187], v[40:43], v[136:139]
    ds_read_b64_tr_b16 v[168:169], v194 offset:0
    v_mfma_f32_16x16x32_bf16 v[152:155], v[184:187], v[44:47], v[152:155]
    ds_read_b64_tr_b16 v[170:171], v194 offset:512
    buffer_load_dwordx4 v[36:39], v2, s[24:27], s76 offen offset:1024 sc1
    s_waitcnt lgkmcnt(6)
    v_mfma_f32_16x16x32_bf16 v[140:143], v[188:191], v[40:43], v[140:143]
    ds_read_b64_tr_b16 v[172:173], v195 offset:0
    v_mfma_f32_16x16x32_bf16 v[156:159], v[188:191], v[44:47], v[156:159]
    ds_read_b64_tr_b16 v[174:175], v195 offset:512
    s_waitcnt vmcnt(11) lgkmcnt(6)
    v_mfma_f32_16x16x32_bf16 v[128:131], v[160:163], v[48:51], v[128:131]
    ds_read_b64_tr_b16 v[176:177], v192 offset:4096
    s_waitcnt vmcnt(10)
    v_mfma_f32_16x16x32_bf16 v[144:147], v[160:163], v[52:55], v[144:147]
    ds_read_b64_tr_b16 v[178:179], v192 offset:4608
    buffer_load_dwordx4 v[40:43], v2, s[24:27], s75 offen offset:2048 sc1
    s_waitcnt lgkmcnt(6)
    v_mfma_f32_16x16x32_bf16 v[132:135], v[164:167], v[48:51], v[132:135]
    ds_read_b64_tr_b16 v[180:181], v193 offset:4096
    v_mfma_f32_16x16x32_bf16 v[148:151], v[164:167], v[52:55], v[148:151]
    ds_read_b64_tr_b16 v[182:183], v193 offset:4608
    s_waitcnt lgkmcnt(6)
    v_mfma_f32_16x16x32_bf16 v[136:139], v[168:171], v[48:51], v[136:139]
    ds_read_b64_tr_b16 v[184:185], v194 offset:4096
    v_mfma_f32_16x16x32_bf16 v[152:155], v[168:171], v[52:55], v[152:155]
    ds_read_b64_tr_b16 v[186:187], v194 offset:4608
    buffer_load_dwordx4 v[44:47], v2, s[24:27], s76 offen offset:2048 sc1
    s_waitcnt lgkmcnt(6)
    v_mfma_f32_16x16x32_bf16 v[140:143], v[172:175], v[48:51], v[140:143]
    ds_read_b64_tr_b16 v[188:189], v195 offset:4096
    v_mfma_f32_16x16x32_bf16 v[156:159], v[172:175], v[52:55], v[156:159]
    ds_read_b64_tr_b16 v[190:191], v195 offset:4608
    s_waitcnt vmcnt(11) lgkmcnt(6)
    v_mfma_f32_16x16x32_bf16 v[128:131], v[176:179], v[56:59], v[128:131]
    ds_read_b64_tr_b16 v[160:161], v192 offset:8192
    s_waitcnt vmcnt(10)
    v_mfma_f32_16x16x32_bf16 v[144:147], v[176:179], v[60:63], v[144:147]
    ds_read_b64_tr_b16 v[162:163], v192 offset:8704
    buffer_load_dwordx4 v[48:51], v2, s[24:27], s75 offen offset:3072 sc1
    s_add_u32 s78, s78, 4096
    s_and_b32 s78, s78, 0x7fff
    s_add_u32 s75, s77, s78
    s_waitcnt lgkmcnt(6)
    v_mfma_f32_16x16x32_bf16 v[132:135], v[180:183], v[56:59], v[132:135]
    ds_read_b64_tr_b16 v[164:165], v193 offset:8192
    v_mfma_f32_16x16x32_bf16 v[148:151], v[180:183], v[60:63], v[148:151]
    ds_read_b64_tr_b16 v[166:167], v193 offset:8704
    s_waitcnt lgkmcnt(6)
    v_mfma_f32_16x16x32_bf16 v[136:139], v[184:187], v[56:59], v[136:139]
    ds_read_b64_tr_b16 v[168:169], v194 offset:8192
    v_mfma_f32_16x16x32_bf16 v[152:155], v[184:187], v[60:63], v[152:155]
    ds_read_b64_tr_b16 v[170:171], v194 offset:8704
    buffer_load_dwordx4 v[52:55], v2, s[24:27], s76 offen offset:3072 sc1
    s_add_u32 s76, s75, 32768
    s_waitcnt lgkmcnt(6)
    v_mfma_f32_16x16x32_bf16 v[140:143], v[188:191], v[56:59], v[140:143]
    ds_read_b64_tr_b16 v[172:173], v195 offset:8192
    v_mfma_f32_16x16x32_bf16 v[156:159], v[188:191], v[60:63], v[156:159]
    ds_read_b64_tr_b16 v[174:175], v195 offset:8704
    s_waitcnt vmcnt(11) lgkmcnt(6)
    v_mfma_f32_16x16x32_bf16 v[128:131], v[160:163], v[64:67], v[128:131]
    ds_read_b64_tr_b16 v[176:177], v192 offset:12288
    s_waitcnt vmcnt(10)
    v_mfma_f32_16x16x32_bf16 v[144:147], v[160:163], v[68:71], v[144:147]
    ds_read_b64_tr_b16 v[178:179], v192 offset:12800
    buffer_load_dwordx4 v[56:59], v2, s[24:27], s75 offen offset:0 sc1
    s_waitcnt lgkmcnt(6)
    v_mfma_f32_16x16x32_bf16 v[132:135], v[164:167], v[64:67], v[132:135]
    ds_read_b64_tr_b16 v[180:181], v193 offset:12288
    v_mfma_f32_16x16x32_bf16 v[148:151], v[164:167], v[68:71], v[148:151]
    ds_read_b64_tr_b16 v[182:183], v193 offset:12800
    s_waitcnt lgkmcnt(6)
    v_mfma_f32_16x16x32_bf16 v[136:139], v[168:171], v[64:67], v[136:139]
    ds_read_b64_tr_b16 v[184:185], v194 offset:12288
    v_mfma_f32_16x16x32_bf16 v[152:155], v[168:171], v[68:71], v[152:155]
    ds_read_b64_tr_b16 v[186:187], v194 offset:12800
    buffer_load_dwordx4 v[60:63], v2, s[24:27], s76 offen offset:0 sc1
    s_waitcnt lgkmcnt(6)
    v_mfma_f32_16x16x32_bf16 v[140:143], v[172:175], v[64:67], v[140:143]
    ds_read_b64_tr_b16 v[188:189], v195 offset:12288
    v_mfma_f32_16x16x32_bf16 v[156:159], v[172:175], v[68:71], v[156:159]
    ds_read_b64_tr_b16 v[190:191], v195 offset:12800
    s_waitcnt vmcnt(11) lgkmcnt(6)
    v_mfma_f32_16x16x32_bf16 v[128:131], v[176:179], v[72:75], v[128:131]
    ds_read_b64_tr_b16 v[160:161], v192 offset:16384
    s_waitcnt vmcnt(10)
    v_mfma_f32_16x16x32_bf16 v[144:147], v[176:179], v[76:79], v[144:147]
    ds_read_b64_tr_b16 v[162:163], v192 offset:16896
    buffer_load_dwordx4 v[64:67], v2, s[24:27], s75 offen offset:1024 sc1
    s_waitcnt lgkmcnt(6)
    v_mfma_f32_16x16x32_bf16 v[132:135], v[180:183], v[72:75], v[132:135]
    ds_read_b64_tr_b16 v[164:165], v193 offset:16384
    v_mfma_f32_16x16x32_bf16 v[148:151], v[180:183], v[76:79], v[148:151]
    ds_read_b64_tr_b16 v[166:167], v193 offset:16896
    s_waitcnt lgkmcnt(6)
    v_mfma_f32_16x16x32_bf16 v[136:139], v[184:187], v[72:75], v[136:139]
    ds_read_b64_tr_b16 v[168:169], v194 offset:16384
    v_mfma_f32_16x16x32_bf16 v[152:155], v[184:187], v[76:79], v[152:155]
    ds_read_b64_tr_b16 v[170:171], v194 offset:16896
    buffer_load_dwordx4 v[68:71], v2, s[24:27], s76 offen offset:1024 sc1
    s_waitcnt lgkmcnt(6)
    v_mfma_f32_16x16x32_bf16 v[140:143], v[188:191], v[72:75], v[140:143]
    ds_read_b64_tr_b16 v[172:173], v195 offset:16384
    v_mfma_f32_16x16x32_bf16 v[156:159], v[188:191], v[76:79], v[156:159]
    ds_read_b64_tr_b16 v[174:175], v195 offset:16896
    s_waitcnt vmcnt(11) lgkmcnt(6)
    v_mfma_f32_16x16x32_bf16 v[128:131], v[160:163], v[80:83], v[128:131]
    ds_read_b64_tr_b16 v[176:177], v192 offset:20480
    s_waitcnt vmcnt(10)
    v_mfma_f32_16x16x32_bf16 v[144:147], v[160:163], v[84:87], v[144:147]
    ds_read_b64_tr_b16 v[178:179], v192 offset:20992
    buffer_load_dwordx4 v[72:75], v2, s[24:27], s75 offen offset:2048 sc1
    s_waitcnt lgkmcnt(6)
    v_mfma_f32_16x16x32_bf16 v[132:135], v[164:167], v[80:83], v[132:135]
    ds_read_b64_tr_b16 v[180:181], v193 offset:20480
    v_mfma_f32_16x16x32_bf16 v[148:151], v[164:167], v[84:87], v[148:151]
    ds_read_b64_tr_b16 v[182:183], v193 offset:20992
    s_waitcnt lgkmcnt(6)
    v_mfma_f32_16x16x32_bf16 v[136:139], v[168:171], v[80:83], v[136:139]
    ds_read_b64_tr_b16 v[184:185], v194 offset:20480
    v_mfma_f32_16x16x32_bf16 v[152:155], v[168:171], v[84:87], v[152:155]
    ds_read_b64_tr_b16 v[186:187], v194 offset:20992
    buffer_load_dwordx4 v[76:79], v2, s[24:27], s76 offen offset:2048 sc1
    s_waitcnt lgkmcnt(6)
    v_mfma_f32_16x16x32_bf16 v[140:143], v[172:175], v[80:83], v[140:143]
    ds_read_b64_tr_b16 v[188:189], v195 offset:20480
    v_mfma_f32_16x16x32_bf16 v[156:159], v[172:175], v[84:87], v[156:159]
    ds_read_b64_tr_b16 v[190:191], v195 offset:20992
    s_waitcnt vmcnt(11) lgkmcnt(6)
    v_mfma_f32_16x16x32_bf16 v[128:131], v[176:179], v[32:35], v[128:131]
    ds_read_b64_tr_b16 v[160:161], v192 offset:24576
    s_waitcnt vmcnt(10)
    v_mfma_f32_16x16x32_bf16 v[144:147], v[176:179], v[36:39], v[144:147]
    ds_read_b64_tr_b16 v[162:163], v192 offset:25088
    buffer_load_dwordx4 v[80:83], v2, s[24:27], s75 offen offset:3072 sc1
    s_add_u32 s78, s78, 4096
    s_and_b32 s78, s78, 0x7fff
    s_add_u32 s75, s77, s78
    s_waitcnt lgkmcnt(6)
    v_mfma_f32_16x16x32_bf16 v[132:135], v[180:183], v[32:35], v[132:135]
    ds_read_b64_tr_b16 v[164:165], v193 offset:24576
    v_mfma_f32_16x16x32_bf16 v[148:151], v[180:183], v[36:39], v[148:151]
    ds_read_b64_tr_b16 v[166:167], v193 offset:25088
    s_waitcnt lgkmcnt(6)
    v_mfma_f32_16x16x32_bf16 v[136:139], v[184:187], v[32:35], v[136:139]
    ds_read_b64_tr_b16 v[168:169], v194 offset:24576
    v_mfma_f32_16x16x32_bf16 v[152:155], v[184:187], v[36:39], v[152:155]
    ds_read_b64_tr_b16 v[170:171], v194 offset:25088
    buffer_load_dwordx4 v[84:87], v2, s[24:27], s76 offen offset:3072 sc1
    s_add_u32 s76, s75, 32768
    s_waitcnt lgkmcnt(6)
    v_mfma_f32_16x16x32_bf16 v[140:143], v[188:191], v[32:35], v[140:143]
    ds_read_b64_tr_b16 v[172:173], v195 offset:24576
    v_mfma_f32_16x16x32_bf16 v[156:159], v[188:191], v[36:39], v[156:159]
    ds_read_b64_tr_b16 v[174:175], v195 offset:25088
    s_waitcnt vmcnt(11) lgkmcnt(6)
    v_mfma_f32_16x16x32_bf16 v[128:131], v[160:163], v[40:43], v[128:131]
    ds_read_b64_tr_b16 v[176:177], v192 offset:28672
    s_waitcnt vmcnt(10)
    v_mfma_f32_16x16x32_bf16 v[144:147], v[160:163], v[44:47], v[144:147]
    ds_read_b64_tr_b16 v[178:179], v192 offset:29184
    buffer_load_dwordx4 v[32:35], v2, s[24:27], s75 offen offset:0 sc1
    s_waitcnt lgkmcnt(6)
    v_mfma_f32_16x16x32_bf16 v[132:135], v[164:167], v[40:43], v[132:135]
    ds_read_b64_tr_b16 v[180:181], v193 offset:28672
    v_mfma_f32_16x16x32_bf16 v[148:151], v[164:167], v[44:47], v[148:151]
    ds_read_b64_tr_b16 v[182:183], v193 offset:29184
    s_waitcnt lgkmcnt(6)
    v_mfma_f32_16x16x32_bf16 v[136:139], v[168:171], v[40:43], v[136:139]
    ds_read_b64_tr_b16 v[184:185], v194 offset:28672
    v_mfma_f32_16x16x32_bf16 v[152:155], v[168:171], v[44:47], v[152:155]
    ds_read_b64_tr_b16 v[186:187], v194 offset:29184
    buffer_load_dwordx4 v[36:39], v2, s[24:27], s76 offen offset:0 sc1
    s_waitcnt lgkmcnt(6)
    v_mfma_f32_16x16x32_bf16 v[140:143], v[172:175], v[40:43], v[140:143]
    ds_read_b64_tr_b16 v[188:189], v195 offset:28672
    v_mfma_f32_16x16x32_bf16 v[156:159], v[172:175], v[44:47], v[156:159]
    ds_read_b64_tr_b16 v[190:191], v195 offset:29184
    s_waitcnt vmcnt(11) lgkmcnt(6)
    v_mfma_f32_16x16x32_bf16 v[128:131], v[176:179], v[48:51], v[128:131]
    ds_read_b64_tr_b16 v[160:161], v192 offset:32768
    s_waitcnt vmcnt(10)
    v_mfma_f32_16x16x32_bf16 v[144:147], v[176:179], v[52:55], v[144:147]
    ds_read_b64_tr_b16 v[162:163], v192 offset:33280
    buffer_load_dwordx4 v[40:43], v2, s[24:27], s75 offen offset:1024 sc1
    s_waitcnt lgkmcnt(6)
    v_mfma_f32_16x16x32_bf16 v[132:135], v[180:183], v[48:51], v[132:135]
    ds_read_b64_tr_b16 v[164:165], v193 offset:32768
    v_mfma_f32_16x16x32_bf16 v[148:151], v[180:183], v[52:55], v[148:151]
    ds_read_b64_tr_b16 v[166:167], v193 offset:33280
    s_waitcnt lgkmcnt(6)
    v_mfma_f32_16x16x32_bf16 v[136:139], v[184:187], v[48:51], v[136:139]
    ds_read_b64_tr_b16 v[168:169], v194 offset:32768
    v_mfma_f32_16x16x32_bf16 v[152:155], v[184:187], v[52:55], v[152:155]
    ds_read_b64_tr_b16 v[170:171], v194 offset:33280
    buffer_load_dwordx4 v[44:47], v2, s[24:27], s76 offen offset:1024 sc1
    s_waitcnt lgkmcnt(6)
    v_mfma_f32_16x16x32_bf16 v[140:143], v[188:191], v[48:51], v[140:143]
    ds_read_b64_tr_b16 v[172:173], v195 offset:32768
    v_mfma_f32_16x16x32_bf16 v[156:159], v[188:191], v[52:55], v[156:159]
    ds_read_b64_tr_b16 v[174:175], v195 offset:33280
    s_waitcnt vmcnt(11) lgkmcnt(6)
    v_mfma_f32_16x16x32_bf16 v[128:131], v[160:163], v[56:59], v[128:131]
    ds_read_b64_tr_b16 v[176:177], v192 offset:36864
    s_waitcnt vmcnt(10)
    v_mfma_f32_16x16x32_bf16 v[144:147], v[160:163], v[60:63], v[144:147]
    ds_read_b64_tr_b16 v[178:179], v192 offset:37376
    buffer_load_dwordx4 v[48:51], v2, s[24:27], s75 offen offset:2048 sc1
    s_waitcnt lgkmcnt(6)
    v_mfma_f32_16x16x32_bf16 v[132:135], v[164:167], v[56:59], v[132:135]
    ds_read_b64_tr_b16 v[180:181], v193 offset:36864
    v_mfma_f32_16x16x32_bf16 v[148:151], v[164:167], v[60:63], v[148:151]
    ds_read_b64_tr_b16 v[182:183], v193 offset:37376
    s_waitcnt lgkmcnt(6)
    v_mfma_f32_16x16x32_bf16 v[136:139], v[168:171], v[56:59], v[136:139]
    ds_read_b64_tr_b16 v[184:185], v194 offset:36864
    v_mfma_f32_16x16x32_bf16 v[152:155], v[168:171], v[60:63], v[152:155]
    ds_read_b64_tr_b16 v[186:187], v194 offset:37376
    buffer_load_dwordx4 v[52:55], v2, s[24:27], s76 offen offset:2048 sc1
    s_waitcnt lgkmcnt(6)
    v_mfma_f32_16x16x32_bf16 v[140:143], v[172:175], v[56:59], v[140:143]
    ds_read_b64_tr_b16 v[188:189], v195 offset:36864
    v_mfma_f32_16x16x32_bf16 v[156:159], v[172:175], v[60:63], v[156:159]
    ds_read_b64_tr_b16 v[190:191], v195 offset:37376
    s_waitcnt vmcnt(11) lgkmcnt(6)
    v_mfma_f32_16x16x32_bf16 v[128:131], v[176:179], v[64:67], v[128:131]
    ds_read_b64_tr_b16 v[160:161], v192 offset:40960
    s_waitcnt vmcnt(10)
    v_mfma_f32_16x16x32_bf16 v[144:147], v[176:179], v[68:71], v[144:147]
    ds_read_b64_tr_b16 v[162:163], v192 offset:41472
    buffer_load_dwordx4 v[56:59], v2, s[24:27], s75 offen offset:3072 sc1
    s_waitcnt lgkmcnt(6)
    v_mfma_f32_16x16x32_bf16 v[132:135], v[180:183], v[64:67], v[132:135]
    ds_read_b64_tr_b16 v[164:165], v193 offset:40960
    v_mfma_f32_16x16x32_bf16 v[148:151], v[180:183], v[68:71], v[148:151]
    ds_read_b64_tr_b16 v[166:167], v193 offset:41472
    s_waitcnt lgkmcnt(6)
    v_mfma_f32_16x16x32_bf16 v[136:139], v[184:187], v[64:67], v[136:139]
    ds_read_b64_tr_b16 v[168:169], v192 offset:45056
    v_mfma_f32_16x16x32_bf16 v[152:155], v[184:187], v[68:71], v[152:155]
    ds_read_b64_tr_b16 v[170:171], v192 offset:45568
    buffer_load_dwordx4 v[60:63], v2, s[24:27], s76 offen offset:3072 sc1
    s_waitcnt lgkmcnt(6)
    v_mfma_f32_16x16x32_bf16 v[140:143], v[188:191], v[64:67], v[140:143]
    ds_read_b64_tr_b16 v[172:173], v193 offset:45056
    v_mfma_f32_16x16x32_bf16 v[156:159], v[188:191], v[68:71], v[156:159]
    ds_read_b64_tr_b16 v[174:175], v193 offset:45568
    s_barrier
    s_waitcnt vmcnt(11) lgkmcnt(6)
    v_mfma_f32_16x16x32_bf16 v[128:131], v[160:163], v[72:75], v[128:131]
    ds_read_b64_tr_b16 v[176:177], v192 offset:49152
    s_waitcnt vmcnt(10)
    v_mfma_f32_16x16x32_bf16 v[144:147], v[160:163], v[76:79], v[144:147]
    ds_read_b64_tr_b16 v[178:179], v192 offset:49664
    s_waitcnt lgkmcnt(6)
    v_mfma_f32_16x16x32_bf16 v[132:135], v[164:167], v[72:75], v[132:135]
    ds_read_b64_tr_b16 v[180:181], v193 offset:49152
    v_mfma_f32_16x16x32_bf16 v[148:151], v[164:167], v[76:79], v[148:151]
    ds_read_b64_tr_b16 v[182:183], v193 offset:49664
    s_waitcnt vmcnt(9) lgkmcnt(6)
    v_mfma_f32_16x16x32_bf16 v[128:131], v[168:171], v[80:83], v[128:131]
    ds_read_b64_tr_b16 v[184:185], v192 offset:53248
    s_waitcnt vmcnt(8)
    v_mfma_f32_16x16x32_bf16 v[144:147], v[168:171], v[84:87], v[144:147]
    ds_read_b64_tr_b16 v[186:187], v192 offset:53760
    s_waitcnt lgkmcnt(6)
    v_mfma_f32_16x16x32_bf16 v[132:135], v[172:175], v[80:83], v[132:135]
    ds_read_b64_tr_b16 v[188:189], v193 offset:53248
    v_mfma_f32_16x16x32_bf16 v[148:151], v[172:175], v[84:87], v[148:151]
    ds_read_b64_tr_b16 v[190:191], v193 offset:53760
    s_waitcnt vmcnt(7) lgkmcnt(6)
    v_mfma_f32_16x16x32_bf16 v[128:131], v[176:179], v[32:35], v[128:131]
    ds_read_b64_tr_b16 v[160:161], v192 offset:57344
    s_waitcnt vmcnt(6)
    v_mfma_f32_16x16x32_bf16 v[144:147], v[176:179], v[36:39], v[144:147]
    ds_read_b64_tr_b16 v[162:163], v192 offset:57856
    s_waitcnt lgkmcnt(6)
    v_mfma_f32_16x16x32_bf16 v[132:135], v[180:183], v[32:35], v[132:135]
    ds_read_b64_tr_b16 v[164:165], v193 offset:57344
    v_mfma_f32_16x16x32_bf16 v[148:151], v[180:183], v[36:39], v[148:151]
    ds_read_b64_tr_b16 v[166:167], v193 offset:57856
    s_waitcnt vmcnt(5) lgkmcnt(6)
    v_mfma_f32_16x16x32_bf16 v[128:131], v[184:187], v[40:43], v[128:131]
    ds_read_b64_tr_b16 v[168:169], v192 offset:61440
    s_waitcnt vmcnt(4)
    v_mfma_f32_16x16x32_bf16 v[144:147], v[184:187], v[44:47], v[144:147]
    ds_read_b64_tr_b16 v[170:171], v192 offset:61952
    s_waitcnt lgkmcnt(6)
    v_mfma_f32_16x16x32_bf16 v[132:135], v[188:191], v[40:43], v[132:135]
    ds_read_b64_tr_b16 v[172:173], v193 offset:61440
    v_mfma_f32_16x16x32_bf16 v[148:151], v[188:191], v[44:47], v[148:151]
    ds_read_b64_tr_b16 v[174:175], v193 offset:61952
    s_waitcnt vmcnt(3) lgkmcnt(6)
    v_mfma_f32_16x16x32_bf16 v[128:131], v[160:163], v[48:51], v[128:131]
    ds_read_b64_tr_b16 v[176:177], v194 offset:40960
    s_waitcnt vmcnt(2)
    v_mfma_f32_16x16x32_bf16 v[144:147], v[160:163], v[52:55], v[144:147]
    ds_read_b64_tr_b16 v[178:179], v194 offset:41472
    s_waitcnt lgkmcnt(6)
    v_mfma_f32_16x16x32_bf16 v[132:135], v[164:167], v[48:51], v[132:135]
    ds_read_b64_tr_b16 v[180:181], v195 offset:40960
    v_mfma_f32_16x16x32_bf16 v[148:151], v[164:167], v[52:55], v[148:151]
    ds_read_b64_tr_b16 v[182:183], v195 offset:41472
    s_waitcnt vmcnt(1) lgkmcnt(6)
    v_mfma_f32_16x16x32_bf16 v[128:131], v[168:171], v[56:59], v[128:131]
    ds_read_b64_tr_b16 v[184:185], v194 offset:45056
    s_waitcnt vmcnt(0)
    v_mfma_f32_16x16x32_bf16 v[144:147], v[168:171], v[60:63], v[144:147]
    ds_read_b64_tr_b16 v[186:187], v194 offset:45568
    s_waitcnt lgkmcnt(6)
    v_mfma_f32_16x16x32_bf16 v[132:135], v[172:175], v[56:59], v[132:135]
    ds_read_b64_tr_b16 v[188:189], v195 offset:45056
    v_mfma_f32_16x16x32_bf16 v[148:151], v[172:175], v[60:63], v[148:151]
    ds_read_b64_tr_b16 v[190:191], v195 offset:45568
    s_waitcnt lgkmcnt(6)
    v_mfma_f32_16x16x32_bf16 v[136:139], v[176:179], v[72:75], v[136:139]
    ds_read_b64_tr_b16 v[160:161], v194 offset:49152
    v_mfma_f32_16x16x32_bf16 v[152:155], v[176:179], v[76:79], v[152:155]
    ds_read_b64_tr_b16 v[162:163], v194 offset:49664
    s_waitcnt lgkmcnt(6)
    v_mfma_f32_16x16x32_bf16 v[140:143], v[180:183], v[72:75], v[140:143]
    ds_read_b64_tr_b16 v[164:165], v195 offset:49152
    v_cvt_pk_bf16_f32 v16, v128, v129
    v_cvt_pk_bf16_f32 v18, v132, v133
    v_mfma_f32_16x16x32_bf16 v[156:159], v[180:183], v[76:79], v[156:159]
    ds_read_b64_tr_b16 v[166:167], v195 offset:49664
    v_cvt_pk_bf16_f32 v17, v130, v131
    v_cvt_pk_bf16_f32 v19, v134, v135
    s_waitcnt lgkmcnt(6)
    v_mfma_f32_16x16x32_bf16 v[136:139], v[184:187], v[80:83], v[136:139]
    ds_read_b64_tr_b16 v[168:169], v194 offset:53248
    v_cvt_pk_bf16_f32 v24, v144, v145
    v_cvt_pk_bf16_f32 v26, v148, v149
    v_mfma_f32_16x16x32_bf16 v[152:155], v[184:187], v[84:87], v[152:155]
    ds_read_b64_tr_b16 v[170:171], v194 offset:53760
    v_permlane16_swap_b32 v16, v18
    v_permlane16_swap_b32 v17, v19
    s_waitcnt lgkmcnt(6)
    v_mfma_f32_16x16x32_bf16 v[140:143], v[188:191], v[80:83], v[140:143]
    ds_read_b64_tr_b16 v[172:173], v195 offset:53248
    v_cvt_pk_bf16_f32 v25, v146, v147
    v_cvt_pk_bf16_f32 v27, v150, v151
    v_mfma_f32_16x16x32_bf16 v[156:159], v[188:191], v[84:87], v[156:159]
    ds_read_b64_tr_b16 v[174:175], v195 offset:53760
    buffer_store_dwordx4 v[16:19], v15, s[40:43], s71 offen sc1
    v_permlane16_swap_b32 v24, v26
    s_waitcnt lgkmcnt(6)
    v_mfma_f32_16x16x32_bf16 v[136:139], v[160:163], v[32:35], v[136:139]
    ds_read_b64_tr_b16 v[176:177], v194 offset:57344
    v_permlane16_swap_b32 v25, v27
    ds_write_b128 v206, v[16:19] offset:0
    v_mfma_f32_16x16x32_bf16 v[152:155], v[160:163], v[36:39], v[152:155]
    ds_read_b64_tr_b16 v[178:179], v194 offset:57856
    buffer_store_dwordx4 v[24:27], v15, s[40:43], s73 offen sc1
    ds_write_b128 v206, v[24:27] offset:2048
    s_waitcnt lgkmcnt(8)
    v_mfma_f32_16x16x32_bf16 v[140:143], v[164:167], v[32:35], v[140:143]
    ds_read_b64_tr_b16 v[180:181], v195 offset:57344
    v_mfma_f32_16x16x32_bf16 v[156:159], v[164:167], v[36:39], v[156:159]
    ds_read_b64_tr_b16 v[182:183], v195 offset:57856
    s_waitcnt lgkmcnt(8)
    v_mfma_f32_16x16x32_bf16 v[136:139], v[168:171], v[40:43], v[136:139]
    ds_read_b64_tr_b16 v[184:185], v194 offset:61440
    v_mfma_f32_16x16x32_bf16 v[152:155], v[168:171], v[44:47], v[152:155]
    ds_read_b64_tr_b16 v[186:187], v194 offset:61952
    s_waitcnt lgkmcnt(8)
    v_mfma_f32_16x16x32_bf16 v[140:143], v[172:175], v[40:43], v[140:143]
    ds_read_b64_tr_b16 v[188:189], v195 offset:61440
    v_mfma_f32_16x16x32_bf16 v[156:159], v[172:175], v[44:47], v[156:159]
    ds_read_b64_tr_b16 v[190:191], v195 offset:61952
    s_waitcnt lgkmcnt(7)
    v_mfma_f32_16x16x32_bf16 v[136:139], v[176:179], v[48:51], v[136:139]
    v_mfma_f32_16x16x32_bf16 v[152:155], v[176:179], v[52:55], v[152:155]
    s_waitcnt lgkmcnt(4)
    v_mfma_f32_16x16x32_bf16 v[140:143], v[180:183], v[48:51], v[140:143]
    v_mfma_f32_16x16x32_bf16 v[156:159], v[180:183], v[52:55], v[156:159]
    s_waitcnt lgkmcnt(2)
    v_mfma_f32_16x16x32_bf16 v[136:139], v[184:187], v[56:59], v[136:139]
    v_mfma_f32_16x16x32_bf16 v[152:155], v[184:187], v[60:63], v[152:155]
    s_waitcnt lgkmcnt(0)
    v_mfma_f32_16x16x32_bf16 v[140:143], v[188:191], v[56:59], v[140:143]
    v_mfma_f32_16x16x32_bf16 v[156:159], v[188:191], v[60:63], v[156:159]
    s_nop 3
    v_cvt_pk_bf16_f32 v20, v136, v137
    s_nop 1
    v_cvt_pk_bf16_f32 v22, v140, v141
    v_cvt_pk_bf16_f32 v21, v138, v139
    v_cvt_pk_bf16_f32 v23, v142, v143
    v_cvt_pk_bf16_f32 v28, v152, v153
    v_cvt_pk_bf16_f32 v30, v156, v157
    v_cvt_pk_bf16_f32 v29, v154, v155
    v_cvt_pk_bf16_f32 v31, v158, v159
    v_permlane16_swap_b32 v20, v22
    v_permlane16_swap_b32 v21, v23
    buffer_store_dwordx4 v[20:23], v15, s[40:43], s72 offen sc1
    v_permlane16_swap_b32 v28, v30
    v_permlane16_swap_b32 v29, v31
    buffer_store_dwordx4 v[28:31], v15, s[40:43], s74 offen sc1
    ds_write_b128 v206, v[20:23] offset:1024
    ds_write_b128 v206, v[28:31] offset:3072
    s_cmp_eq_u32 s51, 3
    s_cbranch_scc1 L_fin
    s_add_u32 s86, s86, 4096
    s_add_u32 s87, s87, 131072
    s_add_u32 s51, s51, 1
    s_waitcnt lgkmcnt(0)
    s_branch L_first
L_loader:
    s_sub_u32 s65, s50, 4
    v_lshrrev_b32 v2, 3, v1
    v_mul_u32_u24 v2, 6144, v2
    v_and_b32 v3, 7, v1
    v_bfe_u32 v4, v1, 4, 1
    v_lshlrev_b32 v4, 1, v4
    v_xor_b32 v3, v3, v4
    v_xor_b32 v4, 4, v3
    v_lshl_add_u32 v3, v3, 4, v2
    v_lshl_add_u32 v4, v4, 4, v2
    s_lshl_b32 s53, s49, 7
    v_add_u32 v3, s53, v3
    s_add_u32 s53, s53, 48128
    v_add_u32 v4, s53, v4
    s_cmp_eq_u32 s65, 0
    s_mov_b32 s52, 198656
    s_cmov_b32 s52, 0
    v_add_u32 v16, s52, v3
    v_add_u32 v17, s52, v4
    v_add_u32 v18, 96256, v16
    v_add_u32 v19, 96256, v17
    s_mov_b32 s52, 4096
    s_cmov_b32 s52, 196608
    v_add_u32 v20, s52, v3
    v_add_u32 v21, s52, v4
    v_add_u32 v22, 96256, v20
    v_add_u32 v23, 96256, v21
    s_mov_b32 s52, 200704
    s_cmov_b32 s52, 2048
    v_add_u32 v24, s52, v3
    v_add_u32 v25, s52, v4
    v_add_u32 v26, 96256, v24
    v_add_u32 v27, 96256, v25
    s_mul_i32 s77, s65, 12288
    s_lshl_b32 s69, s65, 13
    s_add_u32 s69, s69, 24576
    s_lshl_b32 s75, s48, 18
    s_mov_b32 s70, 128
    s_mov_b32 s78, 0x76543210
    s_mov_b32 s79, 0xfedcba98
    s_bitcmp1_b32 s48, 2
    s_cselect_b32 s78, 0xba987654, s78
    s_cselect_b32 s79, 0x3210fedc, s79
    s_and_b32 s61, s48, 8
    s_mul_i32 s61, s61, 0x11111111
    s_xor_b32 s78, s78, s61
    s_xor_b32 s79, s79, s61
    s_waitcnt lgkmcnt(0)
    s_mov_b64 s[24:25], s[22:23]
    s_mov_b64 s[28:29], s[4:5]
    s_mov_b64 s[32:33], s[6:7]
    s_mov_b64 s[36:37], s[10:11]
    s_mov_b64 s[40:41], s[22:23]
    s_mov_b64 s[44:45], s[20:21]
    s_lshr_b64 s[12:13], s[78:79], 0
    s_and_b32 s74, s78, 15
    s_lshr_b64 s[78:79], s[78:79], 4
    s_and_b32 s73, s12, 15
    s_lshr_b64 s[12:13], s[12:13], 4
    s_mul_i32 s67, s74, 393216
    s_mul_i32 s66, s73, s70
    s_add_u32 s66, s66, s75
    s_add_u32 m0, s77, 0
    s_nop 0
    buffer_load_dwordx4 v16, s[32:35], s67 offen offset:0 lds
    buffer_load_dwordx4 v17, s[32:35], s67 offen offset:1024 lds
    buffer_load_dwordx4 v18, s[32:35], s67 offen offset:2048 lds
    buffer_load_dwordx4 v19, s[32:35], s67 offen offset:3072 lds
    s_add_u32 m0, m0, 4096
    s_nop 0
    buffer_load_dwordx4 v20, s[32:35], s67 offen offset:0 lds
    buffer_load_dwordx4 v21, s[32:35], s67 offen offset:1024 lds
    buffer_load_dwordx4 v22, s[32:35], s67 offen offset:2048 lds
    buffer_load_dwordx4 v23, s[32:35], s67 offen offset:3072 lds
    s_add_u32 m0, m0, 4096
    s_nop 0
    buffer_load_dwordx4 v24, s[32:35], s67 offen offset:0 lds
    buffer_load_dwordx4 v25, s[32:35], s67 offen offset:1024 lds
    buffer_load_dwordx4 v26, s[32:35], s67 offen offset:2048 lds
    buffer_load_dwordx4 v27, s[32:35], s67 offen offset:3072 lds
    s_and_b32 s74, s78, 15
    s_lshr_b64 s[78:79], s[78:79], 4
    s_mul_i32 s67, s74, 393216
    v_lshrrev_b32 v2, 3, v1
    v_and_b32 v3, 7, v1
    v_lshrrev_b32 v4, 4, v1
    v_xor_b32 v3, v3, v4
    v_xor_b32 v4, 4, v3
    s_lshl_b32 s52, s65, 17
    v_lshl_add_u32 v2, v2, 11, s52
    v_lshl_add_u32 v3, v3, 4, v2
    v_lshl_add_u32 v4, v4, 4, v2
    v_add_u32 v8, 0, v3
    v_add_u32 v9, 15360, v4
    v_add_u32 v10, 30720, v3
    v_add_u32 v11, 46080, v4
    v_add_u32 v12, 65536, v3
    v_add_u32 v13, 80896, v4
    v_add_u32 v14, 96256, v3
    v_add_u32 v15, 111616, v4
    s_add_u32 m0, s69, 0
    s_nop 0
    buffer_load_dwordx4 v8, s[28:31], s66 offen offset:0 sc1 lds
    buffer_load_dwordx4 v9, s[28:31], s66 offen offset:1024 sc1 lds
    buffer_load_dwordx4 v10, s[28:31], s66 offen offset:2048 sc1 lds
    buffer_load_dwordx4 v11, s[28:31], s66 offen offset:3072 sc1 lds
    s_add_u32 m0, m0, 4096
    s_nop 0
    buffer_load_dwordx4 v12, s[28:31], s66 offen offset:0 sc1 lds
    buffer_load_dwordx4 v13, s[28:31], s66 offen offset:1024 sc1 lds
    buffer_load_dwordx4 v14, s[28:31], s66 offen offset:2048 sc1 lds
    buffer_load_dwordx4 v15, s[28:31], s66 offen offset:3072 sc1 lds
    s_and_b32 s73, s12, 15
    s_lshr_b64 s[12:13], s[12:13], 4
    s_mul_i32 s66, s73, s70
    s_add_u32 s66, s66, s75
    s_add_u32 m0, s77, 40960
    s_nop 0
    buffer_load_dwordx4 v16, s[32:35], s67 offen offset:0 lds
    buffer_load_dwordx4 v17, s[32:35], s67 offen offset:1024 lds
    buffer_load_dwordx4 v18, s[32:35], s67 offen offset:2048 lds
    buffer_load_dwordx4 v19, s[32:35], s67 offen offset:3072 lds
    s_add_u32 m0, m0, 4096
    s_nop 0
    buffer_load_dwordx4 v20, s[32:35], s67 offen offset:0 lds
    buffer_load_dwordx4 v21, s[32:35], s67 offen offset:1024 lds
    buffer_load_dwordx4 v22, s[32:35], s67 offen offset:2048 lds
    buffer_load_dwordx4 v23, s[32:35], s67 offen offset:3072 lds
    s_add_u32 m0, m0, 4096
    s_nop 0
    buffer_load_dwordx4 v24, s[32:35], s67 offen offset:0 lds
    buffer_load_dwordx4 v25, s[32:35], s67 offen offset:1024 lds
    buffer_load_dwordx4 v26, s[32:35], s67 offen offset:2048 lds
    buffer_load_dwordx4 v27, s[32:35], s67 offen offset:3072 lds
    s_and_b32 s74, s78, 15
    s_lshr_b64 s[78:79], s[78:79], 4
    s_mul_i32 s67, s74, 393216
    v_lshrrev_b32 v2, 5, v1
    v_lshlrev_b32 v2, 4, v2
    v_bfe_u32 v3, v1, 3, 2
    v_add_u32 v2, v2, v3
    s_lshl_b32 s52, s49, 7
    v_lshl_add_u32 v2, v2, 11, s52
    v_and_b32 v3, 7, v1
    v_bfe_u32 v4, v1, 4, 1
    v_lshlrev_b32 v4, 1, v4
    v_xor_b32 v3, v3, v4
    v_xor_b32 v4, 4, v3
    v_lshl_add_u32 v3, v3, 4, v2
    v_lshl_add_u32 v4, v4, 4, v2
    v_add_u32 v28, 0, v3
    v_add_u32 v29, 7168, v4
    v_add_u32 v30, 14336, v3
    v_add_u32 v31, 21504, v4
    s_waitcnt vmcnt(12)
    s_barrier
    s_add_u32 m0, s69, 40960
    s_nop 0
    buffer_load_dwordx4 v8, s[28:31], s66 offen offset:0 sc1 lds
    buffer_load_dwordx4 v9, s[28:31], s66 offen offset:1024 sc1 lds
    buffer_load_dwordx4 v10, s[28:31], s66 offen offset:2048 sc1 lds
    buffer_load_dwordx4 v11, s[28:31], s66 offen offset:3072 sc1 lds
    s_add_u32 m0, m0, 4096
    s_nop 0
    buffer_load_dwordx4 v12, s[28:31], s66 offen offset:0 sc1 lds
    buffer_load_dwordx4 v13, s[28:31], s66 offen offset:1024 sc1 lds
    buffer_load_dwordx4 v14, s[28:31], s66 offen offset:2048 sc1 lds
    buffer_load_dwordx4 v15, s[28:31], s66 offen offset:3072 sc1 lds
    s_and_b32 s73, s12, 15
    s_lshr_b64 s[12:13], s[12:13], 4
    s_mul_i32 s66, s73, s70
    s_add_u32 s66, s66, s75
    s_add_u32 m0, s77, 81920
    s_nop 0
    buffer_load_dwordx4 v16, s[32:35], s67 offen offset:0 lds
    buffer_load_dwordx4 v17, s[32:35], s67 offen offset:1024 lds
    buffer_load_dwordx4 v18, s[32:35], s67 offen offset:2048 lds
    buffer_load_dwordx4 v19, s[32:35], s67 offen offset:3072 lds
    s_add_u32 m0, m0, 4096
    s_nop 0
    buffer_load_dwordx4 v20, s[32:35], s67 offen offset:0 lds
    buffer_load_dwordx4 v21, s[32:35], s67 offen offset:1024 lds
    buffer_load_dwordx4 v22, s[32:35], s67 offen offset:2048 lds
    buffer_load_dwordx4 v23, s[32:35], s67 offen offset:3072 lds
    s_add_u32 m0, m0, 4096
    s_nop 0
    buffer_load_dwordx4 v24, s[32:35], s67 offen offset:0 lds
    buffer_load_dwordx4 v25, s[32:35], s67 offen offset:1024 lds
    buffer_load_dwordx4 v26, s[32:35], s67 offen offset:2048 lds
    buffer_load_dwordx4 v27, s[32:35], s67 offen offset:3072 lds
    s_and_b32 s74, s78, 15
    s_lshr_b64 s[78:79], s[78:79], 4
    s_mul_i32 s67, s74, 393216
    s_waitcnt vmcnt(12)
    s_barrier
    s_add_u32 m0, s69, 81920
    s_nop 0
    buffer_load_dwordx4 v8, s[28:31], s66 offen offset:0 sc1 lds
    buffer_load_dwordx4 v9, s[28:31], s66 offen offset:1024 sc1 lds
    buffer_load_dwordx4 v10, s[28:31], s66 offen offset:2048 sc1 lds
    buffer_load_dwordx4 v11, s[28:31], s66 offen offset:3072 sc1 lds
    s_add_u32 m0, m0, 4096
    s_nop 0
    buffer_load_dwordx4 v12, s[28:31], s66 offen offset:0 sc1 lds
    buffer_load_dwordx4 v13, s[28:31], s66 offen offset:1024 sc1 lds
    buffer_load_dwordx4 v14, s[28:31], s66 offen offset:2048 sc1 lds
    buffer_load_dwordx4 v15, s[28:31], s66 offen offset:3072 sc1 lds
    s_and_b32 s73, s12, 15
    s_lshr_b64 s[12:13], s[12:13], 4
    s_mul_i32 s66, s73, s70
    s_add_u32 s66, s66, s75
L_ld_enter:
    s_mov_b32 s62, 0
    s_mov_b32 s68, 0
L_ld_enter2:
    s_lshr_b32 s86, s32, 7
    s_add_u32 s86, s86, s49
    s_and_b32 s86, s86, 7
    s_mov_b64 s[40:41], s[36:37]
    s_mov_b32 s42, 2097152
    s_lshl_b32 s90, s2, 13
    s_lshl_b32 s61, s50, 11
    s_add_u32 s90, s90, s61
    s_sub_u32 s90, s90, 0x2000
    s_cmp_eq_u32 s51, 0
    s_cselect_b32 s91, 12, 4
    s_cmp_lt_u32 s51, 2
    s_cselect_b32 s91, s91, 0
    s_and_b32 s52, s48, 3
    s_lshl_b32 s87, s52, 19
    s_lshl_b32 s61, s50, 17
    s_add_u32 s87, s87, s61
    s_lshl_b32 s61, s49, 7
    s_add_u32 s87, s87, s61
    s_sub_u32 s87, s87, 0x80000
L_ld_loop:
    s_cmp_eq_u32 s86, 3
    s_cbranch_scc1 L_wf_35
    s_add_u32 m0, s69, s68
    s_nop 0
    buffer_load_dwordx4 v8, s[28:31], s66 offen offset:0 sc1 lds
    buffer_load_dwordx4 v9, s[28:31], s66 offen offset:1024 sc1 lds
    buffer_load_dwordx4 v10, s[28:31], s66 offen offset:2048 sc1 lds
    buffer_load_dwordx4 v11, s[28:31], s66 offen offset:3072 sc1 lds
    s_add_u32 m0, m0, 4096
    s_nop 0
    buffer_load_dwordx4 v12, s[28:31], s66 offen offset:0 sc1 lds
    buffer_load_dwordx4 v13, s[28:31], s66 offen offset:1024 sc1 lds
    buffer_load_dwordx4 v14, s[28:31], s66 offen offset:2048 sc1 lds
    buffer_load_dwordx4 v15, s[28:31], s66 offen offset:3072 sc1 lds
    s_and_b32 s73, s12, 15
    s_lshr_b64 s[12:13], s[12:13], 4
    s_mul_i32 s66, s73, s70
    s_add_u32 s66, s66, s75
    s_add_u32 m0, s77, s68
    s_nop 0
    buffer_load_dwordx4 v16, s[32:35], s67 offen offset:0 lds
    buffer_load_dwordx4 v17, s[32:35], s67 offen offset:1024 lds
    buffer_load_dwordx4 v18, s[32:35], s67 offen offset:2048 lds
    buffer_load_dwordx4 v19, s[32:35], s67 offen offset:3072 lds
    s_add_u32 m0, m0, 4096
    s_nop 0
    buffer_load_dwordx4 v20, s[32:35], s67 offen offset:0 lds
    buffer_load_dwordx4 v21, s[32:35], s67 offen offset:1024 lds
    buffer_load_dwordx4 v22, s[32:35], s67 offen offset:2048 lds
    buffer_load_dwordx4 v23, s[32:35], s67 offen offset:3072 lds
    s_add_u32 m0, m0, 4096
    s_nop 0
    buffer_load_dwordx4 v24, s[32:35], s67 offen offset:0 lds
    buffer_load_dwordx4 v25, s[32:35], s67 offen offset:1024 lds
    buffer_load_dwordx4 v26, s[32:35], s67 offen offset:2048 lds
    buffer_load_dwordx4 v27, s[32:35], s67 offen offset:3072 lds
    s_and_b32 s74, s78, 15
    s_lshr_b64 s[78:79], s[78:79], 4
    s_mul_i32 s67, s74, 393216
    s_branch L_wfd_36
L_wf_35:
    s_add_u32 m0, s77, s68
    s_nop 0
    buffer_load_dwordx4 v16, s[32:35], s67 offen offset:0 lds
    buffer_load_dwordx4 v17, s[32:35], s67 offen offset:1024 lds
    buffer_load_dwordx4 v18, s[32:35], s67 offen offset:2048 lds
    buffer_load_dwordx4 v19, s[32:35], s67 offen offset:3072 lds
    s_add_u32 m0, m0, 4096
    s_nop 0
    buffer_load_dwordx4 v20, s[32:35], s67 offen offset:0 lds
    buffer_load_dwordx4 v21, s[32:35], s67 offen offset:1024 lds
    buffer_load_dwordx4 v22, s[32:35], s67 offen offset:2048 lds
    buffer_load_dwordx4 v23, s[32:35], s67 offen offset:3072 lds
    s_add_u32 m0, m0, 4096
    s_nop 0
    buffer_load_dwordx4 v24, s[32:35], s67 offen offset:0 lds
    buffer_load_dwordx4 v25, s[32:35], s67 offen offset:1024 lds
    buffer_load_dwordx4 v26, s[32:35], s67 offen offset:2048 lds
    buffer_load_dwordx4 v27, s[32:35], s67 offen offset:3072 lds
    s_and_b32 s74, s78, 15
    s_lshr_b64 s[78:79], s[78:79], 4
    s_mul_i32 s67, s74, 393216
    s_add_u32 m0, s69, s68
    s_nop 0
    buffer_load_dwordx4 v8, s[28:31], s66 offen offset:0 sc1 lds
    buffer_load_dwordx4 v9, s[28:31], s66 offen offset:1024 sc1 lds
    buffer_load_dwordx4 v10, s[28:31], s66 offen offset:2048 sc1 lds
    buffer_load_dwordx4 v11, s[28:31], s66 offen offset:3072 sc1 lds
    s_add_u32 m0, m0, 4096
    s_nop 0
    buffer_load_dwordx4 v12, s[28:31], s66 offen offset:0 sc1 lds
    buffer_load_dwordx4 v13, s[28:31], s66 offen offset:1024 sc1 lds
    buffer_load_dwordx4 v14, s[28:31], s66 offen offset:2048 sc1 lds
    buffer_load_dwordx4 v15, s[28:31], s66 offen offset:3072 sc1 lds
    s_and_b32 s73, s12, 15
    s_lshr_b64 s[12:13], s[12:13], 4
    s_mul_i32 s66, s73, s70
    s_add_u32 s66, s66, s75
L_wfd_36:
    s_cmp_gt_u32 s91, s62
    s_cbranch_scc0 L_skip_37
    s_cmp_eq_u32 s62, 4
    s_cbranch_scc0 L_skip_38
    s_mov_b64 s[40:41], s[14:15]
    s_mov_b32 s42, 6291456
    s_mul_i32 s90, s2, 24576
    s_mul_i32 s61, s50, 6144
    s_add_u32 s90, s90, s61
    s_sub_u32 s90, s90, 0x6000
L_skip_38:
    s_sub_u32 s52, s42, 512
    s_min_u32 s52, s52, s90
    s_buffer_load_dwordx2 s[88:89], s[40:43], s52 offset:60
    s_buffer_load_dwordx2 s[88:89], s[40:43], s52 offset:188
    s_buffer_load_dwordx2 s[88:89], s[40:43], s52 offset:316
    s_buffer_load_dwordx2 s[88:89], s[40:43], s52 offset:444
    s_add_u32 s90, s90, 512
L_skip_37:
    s_add_u32 s68, s68, 40960
    s_cmp_eq_u32 s68, 122880
    s_cselect_b32 s68, 0, s68
    s_add_u32 s62, s62, 1
    s_cmp_lt_u32 s62, 13
    s_waitcnt vmcnt(20)
    s_barrier
    s_cbranch_scc1 L_ld_loop
    s_lshl_b32 s72, s65, 12
    s_add_u32 s72, s72, 0x1e000
    s_lshl_b32 s71, s95, 1
    s_add_u32 s71, s71, s65
    s_add_u32 s71, s71, 0x18
    s_and_b32 s71, s71, 31
    s_lshl_b32 s71, s71, 16
    s_mov_b32 s62, 0
L_wo_39:
    s_mov_b32 m0, s72
    s_add_u32 s72, s72, 8192
    buffer_load_dwordx4 v28, s[36:39], s71 offen offset:0 lds
    buffer_load_dwordx4 v29, s[36:39], s71 offen offset:1024 lds
    buffer_load_dwordx4 v30, s[36:39], s71 offen offset:2048 lds
    buffer_load_dwordx4 v31, s[36:39], s71 offen offset:3072 lds
    s_add_u32 s71, s71, 131072
    s_and_b32 s71, s71, 0x1fffff
    s_add_u32 s62, s62, 1
    s_cmp_lt_u32 s62, 4
    s_cbranch_scc1 L_wo_39
    s_lshl_b32 s72, s65, 12
    s_add_u32 s72, s72, 0xa000
    s_lshl_b32 s71, s95, 1
    s_add_u32 s71, s71, s65
    s_add_u32 s71, s71, 0x4
    s_and_b32 s71, s71, 31
    s_lshl_b32 s71, s71, 16
    s_mov_b32 s62, 0
L_wo_40:
    s_mov_b32 m0, s72
    s_add_u32 s72, s72, 8192
    buffer_load_dwordx4 v28, s[36:39], s71 offen offset:0 lds
    buffer_load_dwordx4 v29, s[36:39], s71 offen offset:1024 lds
    buffer_load_dwordx4 v30, s[36:39], s71 offen offset:2048 lds
    buffer_load_dwordx4 v31, s[36:39], s71 offen offset:3072 lds
    s_add_u32 s71, s71, 131072
    s_and_b32 s71, s71, 0x1fffff
    s_add_u32 s62, s62, 1
    s_cmp_lt_u32 s62, 1
    s_cbranch_scc1 L_wo_40
    s_waitcnt vmcnt(20)
    s_barrier
    s_lshl_b32 s72, s65, 12
    s_add_u32 s72, s72, 0xc000
    s_lshl_b32 s71, s95, 1
    s_add_u32 s71, s71, s65
    s_add_u32 s71, s71, 0x6
    s_and_b32 s71, s71, 31
    s_lshl_b32 s71, s71, 16
    s_mov_b32 s62, 0
L_wo_41:
    s_mov_b32 m0, s72
    s_add_u32 s72, s72, 8192
    buffer_load_dwordx4 v28, s[36:39], s71 offen offset:0 lds
    buffer_load_dwordx4 v29, s[36:39], s71 offen offset:1024 lds
    buffer_load_dwordx4 v30, s[36:39], s71 offen offset:2048 lds
    buffer_load_dwordx4 v31, s[36:39], s71 offen offset:3072 lds
    s_add_u32 s71, s71, 131072
    s_and_b32 s71, s71, 0x1fffff
    s_add_u32 s62, s62, 1
    s_cmp_lt_u32 s62, 6
    s_cbranch_scc1 L_wo_41
    s_barrier
    s_lshl_b32 s72, s65, 12
    s_add_u32 s72, s72, 0x18000
    s_lshl_b32 s71, s95, 1
    s_add_u32 s71, s71, s65
    s_add_u32 s71, s71, 0x12
    s_and_b32 s71, s71, 31
    s_lshl_b32 s71, s71, 16
    s_mov_b32 s62, 0
L_wo_42:
    s_mov_b32 m0, s72
    s_add_u32 s72, s72, 8192
    buffer_load_dwordx4 v28, s[36:39], s71 offen offset:0 lds
    buffer_load_dwordx4 v29, s[36:39], s71 offen offset:1024 lds
    buffer_load_dwordx4 v30, s[36:39], s71 offen offset:2048 lds
    buffer_load_dwordx4 v31, s[36:39], s71 offen offset:3072 lds
    s_add_u32 s71, s71, 131072
    s_and_b32 s71, s71, 0x1fffff
    s_add_u32 s62, s62, 1
    s_cmp_lt_u32 s62, 3
    s_cbranch_scc1 L_wo_42
    s_lshl_b32 s72, s65, 12
    s_add_u32 s72, s72, 0x6000
    s_lshl_b32 s71, s95, 1
    s_add_u32 s71, s71, s65
    s_and_b32 s71, s71, 31
    s_lshl_b32 s71, s71, 16
    s_mov_b32 s62, 0
L_wo_43:
    s_mov_b32 m0, s72
    s_add_u32 s72, s72, 8192
    buffer_load_dwordx4 v28, s[36:39], s71 offen offset:0 lds
    buffer_load_dwordx4 v29, s[36:39], s71 offen offset:1024 lds
    buffer_load_dwordx4 v30, s[36:39], s71 offen offset:2048 lds
    buffer_load_dwordx4 v31, s[36:39], s71 offen offset:3072 lds
    s_add_u32 s71, s71, 131072
    s_and_b32 s71, s71, 0x1fffff
    s_add_u32 s62, s62, 1
    s_cmp_lt_u32 s62, 2
    s_cbranch_scc1 L_wo_43
    s_lshl_b32 s76, s51, 13
    s_lshl_b32 s61, s48, 8
    s_add_u32 s76, s76, s61
    s_lshl_b32 s61, s95, 4
    s_add_u32 s76, s76, s61
    s_lshl_b32 s61, s65, 3
    s_add_u32 s76, s76, s61
    s_add_u32 s76, s76, 0x1000
    v_mov_b32 v2, 158464
    ds_read_b32 v2, v2
    s_waitcnt lgkmcnt(0)
    v_readfirstlane_b32 s3, v2
    v_bfe_u32 v5, v1, 1, 3
    v_and_b32 v2, 1, v1
    v_lshl_add_u32 v5, v5, 2, v2
    s_cmp_eq_u32 s3, 1
    s_cselect_b32 s52, 0, 5
    s_cselect_b32 s53, 0, 7340032
    s_lshl_b32 s76, s76, s52
    s_add_u32 s76, s76, s53
    s_add_u32 s52, s52, 2
    v_lshlrev_b32 v5, s52, v5
    s_lshl_b32 s75, s51, 22
    s_lshl_b32 s61, s48, 18
    s_add_u32 s75, s75, s61
    s_add_u32 s75, s75, 0xc00000
    s_bitcmp0_b32 s51, 0
    s_cselect_b64 s[32:33], s[14:15], s[6:7]
    s_cselect_b64 s[36:37], s[16:17], s[10:11]
    s_mov_b64 s[28:29], s[22:23]
    s_mov_b32 s30, 41943040
    s_mov_b32 s70, 16384
    s_and_b32 s52, s49, 7
    s_lshl_b32 s61, s52, 2
    s_lshl_b32 s78, 0x11111110, s61
    s_add_u32 s78, s78, 0x65432100
    s_or_b32 s78, s78, s52
    s_lshr_b32 s61, s48, 2
    s_mul_i32 s79, s61, 0x22222222
    s_add_u32 s79, s79, 0x76543210
    s_or_b32 s79, s79, 0x88888888
    s_mov_b32 s61, s95
    s_mul_i32 s61, s61, 0x11111111
    s_xor_b32 s78, s78, s61
    s_xor_b32 s79, s79, s61
    s_lshr_b64 s[12:13], s[78:79], 4
    s_and_b32 s74, s78, 15
    s_lshr_b64 s[78:79], s[78:79], 4
    s_and_b32 s73, s12, 15
    s_lshr_b64 s[12:13], s[12:13], 4
    s_mul_i32 s67, s74, 393216
    s_mul_i32 s66, s73, s70
    s_add_u32 s66, s66, s75
    s_lshl_b32 s52, s65, 13
    v_lshl_add_u32 v2, v1, 4, s52
    v_add_u32 v8, 0, v2
    v_add_u32 v9, 0, v2
    v_add_u32 v10, 0, v2
    v_add_u32 v11, 0, v2
    v_add_u32 v12, 4096, v2
    v_add_u32 v13, 4096, v2
    v_add_u32 v14, 4096, v2
    v_add_u32 v15, 4096, v2
    s_bitcmp1_b32 s51, 0
    s_cbranch_scc1 L_ld_B
    s_mov_b32 s72, s67
    s_and_b32 s74, s78, 15
    s_lshr_b64 s[78:79], s[78:79], 4
    s_mul_i32 s67, s74, 393216
    s_lshr_b32 s52, 4, s51
    s_bitcmp1_b32 s52, 0
    s_cbranch_scc0 L_skip_44
    buffer_load_dwordx4 v[32:35], v16, s[32:35], s67 offen offset:0
    buffer_load_dwordx4 v[36:39], v17, s[32:35], s67 offen offset:1024
    buffer_load_dwordx4 v[40:43], v18, s[32:35], s67 offen offset:2048
    buffer_load_dwordx4 v[44:47], v19, s[32:35], s67 offen offset:3072
    buffer_load_dwordx4 v[48:51], v20, s[32:35], s67 offen offset:0
    buffer_load_dwordx4 v[52:55], v21, s[32:35], s67 offen offset:1024
    buffer_load_dwordx4 v[56:59], v22, s[32:35], s67 offen offset:2048
    buffer_load_dwordx4 v[60:63], v23, s[32:35], s67 offen offset:3072
    buffer_load_dwordx4 v[64:67], v24, s[32:35], s67 offen offset:0
    buffer_load_dwordx4 v[68:71], v25, s[32:35], s67 offen offset:1024
    buffer_load_dwordx4 v[72:75], v26, s[32:35], s67 offen offset:2048
    buffer_load_dwordx4 v[76:79], v27, s[32:35], s67 offen offset:3072
    s_and_b32 s74, s78, 15
    s_lshr_b64 s[78:79], s[78:79], 4
    s_mul_i32 s67, s74, 393216
    buffer_load_dwordx4 v[80:83], v16, s[32:35], s67 offen offset:0
    buffer_load_dwordx4 v[84:87], v17, s[32:35], s67 offen offset:1024
    buffer_load_dwordx4 v[88:91], v18, s[32:35], s67 offen offset:2048
    buffer_load_dwordx4 v[92:95], v19, s[32:35], s67 offen offset:3072
    buffer_load_dwordx4 v[96:99], v20, s[32:35], s67 offen offset:0
    buffer_load_dwordx4 v[100:103], v21, s[32:35], s67 offen offset:1024
    buffer_load_dwordx4 v[104:107], v22, s[32:35], s67 offen offset:2048
    buffer_load_dwordx4 v[108:111], v23, s[32:35], s67 offen offset:3072
    buffer_load_dwordx4 v[112:115], v24, s[32:35], s67 offen offset:0
    buffer_load_dwordx4 v[116:119], v25, s[32:35], s67 offen offset:1024
    buffer_load_dwordx4 v[120:123], v26, s[32:35], s67 offen offset:2048
    buffer_load_dwordx4 v[124:127], v27, s[32:35], s67 offen offset:3072
    s_and_b32 s74, s78, 15
    s_lshr_b64 s[78:79], s[78:79], 4
    s_mul_i32 s67, s74, 393216
L_skip_44:
    s_lshl_b32 s52, s51, 5
    s_lshl_b32 s61, s49, 2
    s_add_u32 s52, s52, s61
    s_add_u32 s52, s52, s50
    s_sub_u32 s52, s52, 0x4
    s_lshl_b32 s80, s52, 15
    s_lshl_b32 s61, s48, 7
    s_add_u32 s80, s80, s61
    s_add_u32 s80, s80, 0x800000
    s_add_u32 s81, s80, 16384
    s_lshl_b32 s83, s52, 11
    s_lshl_b32 s61, s48, 7
    s_add_u32 s83, s83, s61
    s_add_u32 s83, s83, 0x600000
    s_lshl_b32 s82, s52, 10
    s_add_u32 s82, s82, 0x680000
    s_lshl_b32 s84, s52, 6
    s_add_u32 s84, s84, 0x6c0000
    s_and_b32 s52, s52, 1
    s_xor_b32 s53, s48, s49
    s_or_b32 s52, s52, s53
    s_cselect_b32 s82, 1073741824, s82
    s_cselect_b32 s84, 1073741824, s84
    v_and_b32 v203, 7, v1
    v_lshlrev_b32 v203, 4, v203
    v_lshrrev_b32 v204, 3, v1
    v_lshl_add_u32 v200, v204, 11, v203
    v_lshlrev_b32 v201, 4, v1
    v_lshrrev_b32 v204, 4, v1
    v_lshl_add_u32 v202, v204, 2, v203
    s_cmp_eq_u32 s51, 0
    s_cbranch_scc0 L_skip_45
    v_mov_b32 v208, -1
    v_mov_b32 v209, -1
    v_mov_b32 v210, -1
    v_mov_b32 v211, -1
    s_lshl_b32 s52, s49, 17
    s_lshl_b32 s61, s50, 15
    s_add_u32 s52, s52, s61
    s_lshl_b32 s61, s48, 11
    s_add_u32 s52, s52, s61
    s_add_u32 s52, s52, 0x9e0000
    buffer_store_dwordx4 v[208:211], v201, s[24:27], s52 offen sc1
    buffer_store_dwordx4 v[208:211], v201, s[24:27], s52 offen offset:1024 sc1
    s_lshr_b32 s53, s50, 1
    s_and_b32 s54, s50, 1
    s_lshl_b32 s52, s54, 20
    s_lshl_b32 s61, s48, 16
    s_add_u32 s52, s52, s61
    s_lshl_b32 s61, s49, 12
    s_add_u32 s52, s52, s61
    s_lshl_b32 s61, s53, 11
    s_add_u32 s52, s52, s61
    s_add_u32 s52, s52, 0x3ff000
    buffer_store_dwordx4 v[208:211], v201, s[24:27], s52 offen sc1
    buffer_store_dwordx4 v[208:211], v201, s[24:27], s52 offen offset:1024 sc1
    s_lshl_b32 s52, s50, 18
    s_lshl_b32 s61, s48, 14
    s_add_u32 s52, s52, s61
    s_lshl_b32 s61, s49, 10
    s_add_u32 s52, s52, s61
    s_add_u32 s52, s52, 0x140000
    s_lshl_b32 s55, s49, 14
    s_lshl_b32 s61, s48, 10
    s_add_u32 s55, s55, s61
    s_add_u32 s55, s55, 0x340000
    s_cmp_eq_u32 s50, 7
    s_cselect_b32 s52, s55, s52
    buffer_store_dwordx4 v[208:211], v201, s[24:27], s52 offen sc1
    s_mov_b64 exec, 0xff
    s_add_u32 s52, s83, 131072
    buffer_store_dwordx4 v[208:211], v201, s[24:27], s52 offen sc1
    s_add_u32 s52, s84, 4096
    buffer_store_dwordx4 v[208:211], v201, s[24:27], s52 offen sc1
    s_lshl_b32 s52, s49, 12
    s_lshl_b32 s61, s53, 11
    s_add_u32 s52, s52, s61
    s_lshl_b32 s61, s48, 7
    s_add_u32 s52, s52, s61
    s_add_u32 s52, s52, 0x68f000
    buffer_store_dwordx4 v[208:211], v201, s[24:27], s52 offen sc1
    s_mov_b64 exec, -1
    s_waitcnt vmcnt(0)
L_skip_45:
    s_barrier
    s_setprio 3
    s_barrier
    s_mov_b32 s60, 0
L_spin_46:
    buffer_load_dwordx4 v[208:211], v200, s[24:27], s80 offen sc1
    buffer_load_dwordx4 v[212:215], v200, s[24:27], s81 offen sc1
    buffer_load_dwordx4 v[216:219], v201, s[24:27], s82 offen sc1
    buffer_load_dwordx4 v[220:223], v201, s[24:27], s82 offen offset:1024 sc1
    s_add_u32 s60, s60, 1
    s_cmp_lt_u32 s60, 300000
    s_cbranch_scc0 L_tmo_48
    s_waitcnt vmcnt(3)
    v_max_u32 v203, v208, v209
    v_max3_u32 v203, v203, v210, v211
    s_waitcnt vmcnt(2)
    v_max3_u32 v203, v203, v212, v213
    v_max3_u32 v203, v203, v214, v215
    s_waitcnt vmcnt(1)
    v_max_u32 v204, v216, v217
    v_max3_u32 v204, v204, v218, v219
    s_waitcnt vmcnt(0)
    v_max3_u32 v204, v204, v220, v221
    v_max3_u32 v204, v204, v222, v223
    v_max_u32 v203, v203, v204
    v_cmp_eq_u32 vcc, -1, v203
    s_cbranch_vccnz L_spin_46
L_done_50:
    v_lshlrev_b32 v160, 16, v208
    v_and_b32 v161, 0xffff0000, v208
    v_lshlrev_b32 v162, 16, v209
    v_and_b32 v163, 0xffff0000, v209
    v_lshlrev_b32 v164, 16, v210
    v_and_b32 v165, 0xffff0000, v210
    v_lshlrev_b32 v166, 16, v211
    v_and_b32 v167, 0xffff0000, v211
    v_lshlrev_b32 v168, 16, v212
    v_and_b32 v169, 0xffff0000, v212
    v_lshlrev_b32 v170, 16, v213
    v_and_b32 v171, 0xffff0000, v213
    v_lshlrev_b32 v172, 16, v214
    v_and_b32 v173, 0xffff0000, v214
    v_lshlrev_b32 v174, 16, v215
    v_and_b32 v175, 0xffff0000, v215
    v_lshlrev_b32 v176, 16, v216
    v_and_b32 v177, 0xffff0000, v216
    v_lshlrev_b32 v178, 16, v217
    v_and_b32 v179, 0xffff0000, v217
    v_lshlrev_b32 v180, 16, v218
    v_and_b32 v181, 0xffff0000, v218
    v_lshlrev_b32 v182, 16, v219
    v_and_b32 v183, 0xffff0000, v219
    v_lshlrev_b32 v184, 16, v220
    v_and_b32 v185, 0xffff0000, v220
    v_lshlrev_b32 v186, 16, v221
    v_and_b32 v187, 0xffff0000, v221
    v_lshlrev_b32 v188, 16, v222
    v_and_b32 v189, 0xffff0000, v222
    v_lshlrev_b32 v190, 16, v223
    v_and_b32 v191, 0xffff0000, v223
    v_pk_add_f32 v[160:161], v[160:161], v[168:169]
    v_pk_add_f32 v[162:163], v[162:163], v[170:171]
    v_pk_add_f32 v[164:165], v[164:165], v[172:173]
    v_pk_add_f32 v[166:167], v[166:167], v[174:175]
    v_pk_add_f32 v[176:177], v[176:177], v[184:185]
    v_pk_add_f32 v[178:179], v[178:179], v[186:187]
    v_pk_add_f32 v[180:181], v[180:181], v[188:189]
    v_pk_add_f32 v[182:183], v[182:183], v[190:191]
    v_permlane32_swap_b32 v160, v164
    v_permlane32_swap_b32 v161, v165
    v_permlane32_swap_b32 v162, v166
    v_permlane32_swap_b32 v163, v167
    v_permlane32_swap_b32 v176, v180
    v_permlane32_swap_b32 v177, v181
    v_permlane32_swap_b32 v178, v182
    v_permlane32_swap_b32 v179, v183
    v_pk_add_f32 v[160:161], v[160:161], v[164:165]
    v_pk_add_f32 v[162:163], v[162:163], v[166:167]
    v_pk_add_f32 v[176:177], v[176:177], v[180:181]
    v_pk_add_f32 v[178:179], v[178:179], v[182:183]
    v_permlane16_swap_b32 v160, v162
    v_permlane16_swap_b32 v161, v163
    v_permlane16_swap_b32 v176, v178
    v_permlane16_swap_b32 v177, v179
    v_pk_add_f32 v[160:161], v[160:161], v[162:163]
    v_pk_add_f32 v[176:177], v[176:177], v[178:179]
    s_nop 0
    v_add_f32_dpp v160, v160, v160 row_ror:8 row_mask:0xf bank_mask:0xf
    v_add_f32_dpp v161, v161, v161 row_ror:8 row_mask:0xf bank_mask:0xf
    v_add_f32_dpp v176, v176, v176 row_ror:8 row_mask:0xf bank_mask:0xf
    v_add_f32_dpp v177, v177, v177 row_ror:8 row_mask:0xf bank_mask:0xf
    v_cvt_pk_bf16_f32 v160, v160, v161
    v_cvt_pk_bf16_f32 v176, v176, v177
    s_mov_b32 exec_lo, 0x00ff00ff
    s_mov_b32 exec_hi, 0x00ff00ff
    buffer_store_dword v160, v202, s[24:27], s83 offen sc1
    buffer_store_dword v176, v202, s[24:27], s84 offen sc1
    s_mov_b64 exec, -1
    s_setprio 0
    s_add_u32 m0, s77, 0
    s_nop 0
    buffer_load_dwordx4 v16, s[32:35], s72 offen offset:0 lds
    buffer_load_dwordx4 v17, s[32:35], s72 offen offset:1024 lds
    buffer_load_dwordx4 v18, s[32:35], s72 offen offset:2048 lds
    buffer_load_dwordx4 v19, s[32:35], s72 offen offset:3072 lds
    s_add_u32 m0, m0, 4096
    s_nop 0
    buffer_load_dwordx4 v20, s[32:35], s72 offen offset:0 lds
    buffer_load_dwordx4 v21, s[32:35], s72 offen offset:1024 lds
    buffer_load_dwordx4 v22, s[32:35], s72 offen offset:2048 lds
    buffer_load_dwordx4 v23, s[32:35], s72 offen offset:3072 lds
    s_add_u32 m0, m0, 4096
    s_nop 0
    buffer_load_dwordx4 v24, s[32:35], s72 offen offset:0 lds
    buffer_load_dwordx4 v25, s[32:35], s72 offen offset:1024 lds
    buffer_load_dwordx4 v26, s[32:35], s72 offen offset:2048 lds
    buffer_load_dwordx4 v27, s[32:35], s72 offen offset:3072 lds
    s_waitcnt vmcnt(0)
    s_barrier
    s_branch L_ld_join
L_ld_B:
    s_cmp_lg_u32 s51, 3
    s_cbranch_scc0 L_skip_51
    s_add_u32 m0, s77, 0
    s_nop 0
    buffer_load_dwordx4 v16, s[32:35], s67 offen offset:0 lds
    buffer_load_dwordx4 v17, s[32:35], s67 offen offset:1024 lds
    buffer_load_dwordx4 v18, s[32:35], s67 offen offset:2048 lds
    buffer_load_dwordx4 v19, s[32:35], s67 offen offset:3072 lds
    s_add_u32 m0, m0, 4096
    s_nop 0
    buffer_load_dwordx4 v20, s[32:35], s67 offen offset:0 lds
    buffer_load_dwordx4 v21, s[32:35], s67 offen offset:1024 lds
    buffer_load_dwordx4 v22, s[32:35], s67 offen offset:2048 lds
    buffer_load_dwordx4 v23, s[32:35], s67 offen offset:3072 lds
    s_add_u32 m0, m0, 4096
    s_nop 0
    buffer_load_dwordx4 v24, s[32:35], s67 offen offset:0 lds
    buffer_load_dwordx4 v25, s[32:35], s67 offen offset:1024 lds
    buffer_load_dwordx4 v26, s[32:35], s67 offen offset:2048 lds
    buffer_load_dwordx4 v27, s[32:35], s67 offen offset:3072 lds
    s_and_b32 s74, s78, 15
    s_lshr_b64 s[78:79], s[78:79], 4
    s_mul_i32 s67, s74, 393216
L_skip_51:
L_ld_join:
    s_waitcnt vmcnt(0)
    s_barrier
    s_cmp_eq_u32 s51, 3
    s_cbranch_scc1 L_fin
    s_cmp_eq_u32 s91, 12
    s_cbranch_scc0 L_skip_52
    s_sub_u32 s52, s42, 2048
    s_min_u32 s52, s52, s90
    s_buffer_load_dwordx2 s[88:89], s[40:43], s52 offset:60
    s_buffer_load_dwordx2 s[88:89], s[40:43], s52 offset:188
    s_buffer_load_dwordx2 s[88:89], s[40:43], s52 offset:316
    s_buffer_load_dwordx2 s[88:89], s[40:43], s52 offset:444
    s_buffer_load_dwordx2 s[88:89], s[40:43], s52 offset:572
    s_buffer_load_dwordx2 s[88:89], s[40:43], s52 offset:700
    s_buffer_load_dwordx2 s[88:89], s[40:43], s52 offset:828
    s_buffer_load_dwordx2 s[88:89], s[40:43], s52 offset:956
    s_buffer_load_dwordx2 s[88:89], s[40:43], s52 offset:1084
    s_buffer_load_dwordx2 s[88:89], s[40:43], s52 offset:1212
    s_buffer_load_dwordx2 s[88:89], s[40:43], s52 offset:1340
    s_buffer_load_dwordx2 s[88:89], s[40:43], s52 offset:1468
    s_buffer_load_dwordx2 s[88:89], s[40:43], s52 offset:1596
    s_buffer_load_dwordx2 s[88:89], s[40:43], s52 offset:1724
    s_buffer_load_dwordx2 s[88:89], s[40:43], s52 offset:1852
    s_buffer_load_dwordx2 s[88:89], s[40:43], s52 offset:1980
    s_add_u32 s90, s90, 2048
L_skip_52:
    s_lshr_b32 s52, 4, s51
    s_bitcmp1_b32 s52, 0
    s_cbranch_scc0 L_ld_dma
    s_add_u32 s52, s77, 40960
    v_lshl_add_u32 v3, v1, 4, s52
    s_barrier
    s_barrier
    ds_write_b128 v3, v[32:35] offset:0
    ds_write_b128 v3, v[36:39] offset:1024
    ds_write_b128 v3, v[40:43] offset:2048
    ds_write_b128 v3, v[44:47] offset:3072
    ds_write_b128 v3, v[48:51] offset:4096
    ds_write_b128 v3, v[52:55] offset:5120
    ds_write_b128 v3, v[56:59] offset:6144
    ds_write_b128 v3, v[60:63] offset:7168
    ds_write_b128 v3, v[64:67] offset:8192
    ds_write_b128 v3, v[68:71] offset:9216
    ds_write_b128 v3, v[72:75] offset:10240
    ds_write_b128 v3, v[76:79] offset:11264
    ds_write_b128 v3, v[80:83] offset:40960
    ds_write_b128 v3, v[84:87] offset:41984
    ds_write_b128 v3, v[88:91] offset:43008
    ds_write_b128 v3, v[92:95] offset:44032
    ds_write_b128 v3, v[96:99] offset:45056
    ds_write_b128 v3, v[100:103] offset:46080
    ds_write_b128 v3, v[104:107] offset:47104
    ds_write_b128 v3, v[108:111] offset:48128
    ds_write_b128 v3, v[112:115] offset:49152
    ds_write_b128 v3, v[116:119] offset:50176
    ds_write_b128 v3, v[120:123] offset:51200
    ds_write_b128 v3, v[124:127] offset:52224
    s_waitcnt lgkmcnt(0)
    s_branch L_ld_x
L_ld_dma:
    s_barrier
    s_add_u32 m0, s77, 40960
    s_nop 0
    buffer_load_dwordx4 v16, s[32:35], s67 offen offset:0 lds
    buffer_load_dwordx4 v17, s[32:35], s67 offen offset:1024 lds
    buffer_load_dwordx4 v18, s[32:35], s67 offen offset:2048 lds
    buffer_load_dwordx4 v19, s[32:35], s67 offen offset:3072 lds
    s_add_u32 m0, m0, 4096
    s_nop 0
    buffer_load_dwordx4 v20, s[32:35], s67 offen offset:0 lds
    buffer_load_dwordx4 v21, s[32:35], s67 offen offset:1024 lds
    buffer_load_dwordx4 v22, s[32:35], s67 offen offset:2048 lds
    buffer_load_dwordx4 v23, s[32:35], s67 offen offset:3072 lds
    s_add_u32 m0, m0, 4096
    s_nop 0
    buffer_load_dwordx4 v24, s[32:35], s67 offen offset:0 lds
    buffer_load_dwordx4 v25, s[32:35], s67 offen offset:1024 lds
    buffer_load_dwordx4 v26, s[32:35], s67 offen offset:2048 lds
    buffer_load_dwordx4 v27, s[32:35], s67 offen offset:3072 lds
    s_and_b32 s74, s78, 15
    s_lshr_b64 s[78:79], s[78:79], 4
    s_mul_i32 s67, s74, 393216
    s_barrier
    s_add_u32 m0, s77, 81920
    s_nop 0
    buffer_load_dwordx4 v16, s[32:35], s67 offen offset:0 lds
    buffer_load_dwordx4 v17, s[32:35], s67 offen offset:1024 lds
    buffer_load_dwordx4 v18, s[32:35], s67 offen offset:2048 lds
    buffer_load_dwordx4 v19, s[32:35], s67 offen offset:3072 lds
    s_add_u32 m0, m0, 4096
    s_nop 0
    buffer_load_dwordx4 v20, s[32:35], s67 offen offset:0 lds
    buffer_load_dwordx4 v21, s[32:35], s67 offen offset:1024 lds
    buffer_load_dwordx4 v22, s[32:35], s67 offen offset:2048 lds
    buffer_load_dwordx4 v23, s[32:35], s67 offen offset:3072 lds
    s_add_u32 m0, m0, 4096
    s_nop 0
    buffer_load_dwordx4 v24, s[32:35], s67 offen offset:0 lds
    buffer_load_dwordx4 v25, s[32:35], s67 offen offset:1024 lds
    buffer_load_dwordx4 v26, s[32:35], s67 offen offset:2048 lds
    buffer_load_dwordx4 v27, s[32:35], s67 offen offset:3072 lds
    s_and_b32 s74, s78, 15
    s_lshr_b64 s[78:79], s[78:79], 4
    s_mul_i32 s67, s74, 393216
L_ld_x:
    s_add_u32 s51, s51, 1
    s_setprio 3
    s_mov_b32 s60, 0
    s_cmp_eq_u32 s3, 1
    s_cbranch_scc0 L_alt_56
L_spin_53:
    buffer_load_dword v2, v5, s[24:27], s76 offen nt
    s_add_u32 s60, s60, 1
    s_cmp_lt_u32 s60, 300000
    s_cbranch_scc0 L_tmo_55
    s_waitcnt vmcnt(0)
    v_cmp_eq_u32 vcc, 0, v2
    s_cbranch_vccnz L_spin_53
L_done_57:
    s_add_u32 m0, s69, 40960
    s_nop 0
    buffer_load_dwordx4 v8, s[28:31], s66 offen offset:0 sc1 lds
    buffer_load_dwordx4 v9, s[28:31], s66 offen offset:1024 sc1 lds
    buffer_load_dwordx4 v10, s[28:31], s66 offen offset:2048 sc1 lds
    buffer_load_dwordx4 v11, s[28:31], s66 offen offset:3072 sc1 lds
    s_add_u32 m0, m0, 4096
    s_nop 0
    buffer_load_dwordx4 v12, s[28:31], s66 offen offset:0 sc1 lds
    buffer_load_dwordx4 v13, s[28:31], s66 offen offset:1024 sc1 lds
    buffer_load_dwordx4 v14, s[28:31], s66 offen offset:2048 sc1 lds
    buffer_load_dwordx4 v15, s[28:31], s66 offen offset:3072 sc1 lds
    s_and_b32 s73, s12, 15
    s_lshr_b64 s[12:13], s[12:13], 4
    s_mul_i32 s66, s73, s70
    s_add_u32 s66, s66, s75
    s_add_u32 m0, s69, 81920
    s_nop 0
    buffer_load_dwordx4 v8, s[28:31], s66 offen offset:0 sc1 lds
    buffer_load_dwordx4 v9, s[28:31], s66 offen offset:1024 sc1 lds
    buffer_load_dwordx4 v10, s[28:31], s66 offen offset:2048 sc1 lds
    buffer_load_dwordx4 v11, s[28:31], s66 offen offset:3072 sc1 lds
    s_add_u32 m0, m0, 4096
    s_nop 0
    buffer_load_dwordx4 v12, s[28:31], s66 offen offset:0 sc1 lds
    buffer_load_dwordx4 v13, s[28:31], s66 offen offset:1024 sc1 lds
    buffer_load_dwordx4 v14, s[28:31], s66 offen offset:2048 sc1 lds
    buffer_load_dwordx4 v15, s[28:31], s66 offen offset:3072 sc1 lds
    s_and_b32 s73, s12, 15
    s_lshr_b64 s[12:13], s[12:13], 4
    s_mul_i32 s66, s73, s70
    s_add_u32 s66, s66, s75
    s_setprio 0
    s_waitcnt vmcnt(8)
    s_barrier
    s_branch L_ld_enter
L_helper:
    s_sub_u32 s65, s50, 6
    v_lshlrev_b32 v6, 2, v1
    v_lshlrev_b32 v7, 4, v1
    v_lshrrev_b32 v4, 4, v1
    v_bfe_u32 v2, v1, 2, 2
    v_lshl_add_u32 v3, v4, 3, v2
    v_lshrrev_b32 v2, 1, v2
    v_and_b32 v4, 1, v4
    v_lshl_add_u32 v2, v4, 1, v2
    s_lshl_b32 s52, s65, 1
    v_xor_b32 v2, s52, v2
    v_and_b32 v4, 3, v1
    v_lshlrev_b32 v4, 3, v4
    v_lshl_add_u32 v4, v3, 7, v4
    v_xor_b32 v3, 0, v2
    v_lshl_add_u32 v24, v3, 5, v4
    v_xor_b32 v3, 1, v2
    v_lshl_add_u32 v25, v3, 5, v4
    v_bfe_u32 v21, v1, 1, 3
    v_and_b32 v2, 1, v1
    v_lshl_add_u32 v21, v21, 2, v2
    v_lshlrev_b32 v21, 7, v21
    v_lshrrev_b32 v2, 5, v1
    v_and_b32 v3, 31, v1
    v_lshlrev_b32 v3, 4, v3
    v_lshl_add_u32 v14, v2, 10, v3
    v_and_b32 v4, 24, v1
    v_and_b32 v5, 3, v1
    v_lshl_add_u32 v4, v5, 1, v4
    v_add_u32 v4, v4, v2
    s_lshl_b32 s52, s65, 8
    s_add_u32 s52, s52, 0x26000
    v_lshl_add_u32 v12, v4, 3, s52
    v_mov_b32 v4, 1073741824
    v_cmp_gt_u32 vcc, 384, v3
    s_nop 1
    v_cndmask_b32 v15, v4, v14, vcc
    s_mul_i32 s52, s65, 384
    s_add_u32 s52, s52, 0x26400
    v_lshl_add_u32 v3, v2, 3, v3
    v_add_u32 v13, s52, v3
    s_waitcnt lgkmcnt(0)
    s_mov_b64 s[24:25], s[22:23]
    s_mov_b64 s[28:29], s[4:5]
    s_mov_b64 s[32:33], s[6:7]
    s_mov_b64 s[36:37], s[10:11]
    s_mov_b64 s[40:41], s[22:23]
    s_mov_b64 s[44:45], s[20:21]
    s_and_b32 s56, s48, 3
    s_lshl_b32 s56, s56, 1
    s_add_u32 s56, s56, s65
    s_lshr_b32 s55, s32, 7
    s_sub_u32 s55, 3, s55
    s_and_b32 s55, s55, 7
    s_sub_u32 s54, s49, s55
    s_and_b32 s54, s54, 7
    s_sub_u32 s54, s54, 1
    s_and_b32 s52, s49, 8
    s_add_u32 s55, s55, s52
    s_lshl_b32 s55, s55, 7
    s_bfe_u32 s52, s55, 0x30007
    s_mov_b32 s72, 0x76543210
    s_mov_b32 s73, 0xfedcba98
    s_bitcmp1_b32 s48, 2
    s_cselect_b32 s72, 0xba987654, s72
    s_cselect_b32 s73, 0x3210fedc, s73
    s_and_b32 s61, s48, 8
    s_mul_i32 s61, s61, 0x11111111
    s_xor_b32 s72, s72, s61
    s_xor_b32 s73, s73, s61
    s_cmp_ge_u32 s54, 3
    s_cselect_b32 s52, 190464, 0
    s_add_u32 s55, s55, s52
    s_lshl_b32 s52, s54, 11
    s_add_u32 s55, s55, s52
    s_mul_i32 s52, s56, 24576
    s_add_u32 s55, s55, s52
    s_cmp_lt_u32 s54, 6
    s_cselect_b32 s52, 4, 0
    v_mul_u32_u24 v18, 6144, v1
    v_add_u32 v18, s55, v18
    v_mov_b32 v2, 1073741824
    v_cmp_gt_u32 vcc, s52, v1
    s_nop 1
    v_cndmask_b32 v18, v2, v18, vcc
    s_lshr_b32 s55, s36, 7
    s_sub_u32 s55, 3, s55
    s_and_b32 s55, s55, 7
    s_sub_u32 s54, s49, s55
    s_and_b32 s54, s54, 7
    s_sub_u32 s54, s54, 1
    s_and_b32 s52, s49, 8
    s_add_u32 s55, s55, s52
    s_lshl_b32 s55, s55, 7
    s_lshl_b32 s52, s54, 19
    s_add_u32 s55, s55, s52
    s_mul_i32 s52, s56, 65536
    s_add_u32 s55, s55, s52
    s_cmp_lt_u32 s54, 4
    s_cselect_b32 s52, 8, 0
    s_cselect_b32 s71, s55, -1
    s_mov_b32 s71, -1
    v_lshlrev_b32 v19, 11, v1
    v_add_u32 v19, s55, v19
    v_cmp_gt_u32 vcc, s52, v1
    s_nop 1
    v_cndmask_b32 v19, v2, v19, vcc
    s_bfe_u32 s66, s72, 0x40004
    s_mul_i32 s66, s66, 393216
    buffer_load_dword v20, v18, s[32:35], s66 offen
    s_bfe_u32 s66, s72, 0x40008
    s_mul_i32 s66, s66, 393216
    buffer_load_dword v20, v18, s[32:35], s66 offen
    s_bfe_u32 s66, s72, 0x4000c
    s_mul_i32 s66, s66, 393216
    buffer_load_dword v20, v18, s[32:35], s66 offen
    s_bfe_u32 s66, s72, 0x40010
    s_mul_i32 s66, s66, 393216
    buffer_load_dword v20, v18, s[32:35], s66 offen
    v_mov_b32 v8, 0x3f803f80
    v_mov_b32 v9, 0x3f803f80
    v_mov_b32 v10, 0x3f803f80
    v_mov_b32 v11, 0x3f803f80
    s_mov_b32 s70, 0
L_hp_layer:
    s_lshr_b32 s52, s48, 2
    s_lshl_b32 s52, s52, 1
    s_bitcmp1_b32 s48, 1
    s_cselect_b32 s52, 8, s52
    s_and_b32 s53, s48, 2
    s_cmp_eq_u32 s51, 0
    s_cselect_b32 s52, s53, s52
    s_and_b32 s53, s48, 1
    s_add_u32 s74, s52, s53
    s_mul_i32 s52, s74, 11
    s_lshr_b32 s52, s52, 5
    s_mul_i32 s52, s52, 3
    s_sub_u32 s52, s74, s52
    s_mul_i32 s52, s52, 40960
    v_add_u32 v16, s52, v24
    v_add_u32 v17, s52, v25
    s_cmp_lt_u32 s51, 2
    s_cselect_b32 s74, s74, 99
    s_lshl_b32 s67, s51, 18
    s_lshl_b32 s61, s48, 14
    s_add_u32 s67, s67, s61
    s_lshl_b32 s61, s65, 9
    s_add_u32 s67, s67, s61
    s_add_u32 s67, s67, 0x200000
    s_lshl_b32 s68, s51, 18
    s_lshl_b32 s61, s49, 14
    s_add_u32 s68, s68, s61
    s_mul_i32 s61, s65, 384
    s_add_u32 s68, s68, s61
    s_add_u32 s68, s68, 0x300000
    s_mov_b64 s[40:41], s[36:37]
    s_mov_b32 s42, 2097152
    s_lshl_b32 s90, s2, 13
    s_lshl_b32 s61, s50, 11
    s_add_u32 s90, s90, s61
    s_sub_u32 s90, s90, 0x2000
    s_cmp_eq_u32 s51, 0
    s_cselect_b32 s91, 12, 4
    s_cmp_lt_u32 s51, 2
    s_cselect_b32 s91, s91, 0
    s_and_b32 s52, s48, 3
    s_lshl_b32 s87, s52, 19
    s_lshl_b32 s61, s50, 17
    s_add_u32 s87, s87, s61
    s_lshl_b32 s61, s49, 7
    s_add_u32 s87, s87, s61
    s_sub_u32 s87, s87, 0x80000
    s_barrier
    s_cmp_eq_u32 s74, 0
    s_cbranch_scc0 L_skip_59
    ds_read_b64_tr_b16 v[32:33], v16 offset:0
    ds_read_b64_tr_b16 v[34:35], v16 offset:512
    ds_read_b64_tr_b16 v[36:37], v17 offset:0
    ds_read_b64_tr_b16 v[38:39], v17 offset:512
    ds_read_b64_tr_b16 v[40:41], v16 offset:8192
    ds_read_b64_tr_b16 v[42:43], v16 offset:8704
    ds_read_b64_tr_b16 v[44:45], v17 offset:8192
    ds_read_b64_tr_b16 v[46:47], v17 offset:8704
    ds_read_b64_tr_b16 v[48:49], v16 offset:16384
    ds_read_b64_tr_b16 v[50:51], v16 offset:16896
    ds_read_b64_tr_b16 v[52:53], v17 offset:16384
    ds_read_b64_tr_b16 v[54:55], v17 offset:16896
    ds_read_b64_tr_b16 v[56:57], v16 offset:4096
    ds_read_b64_tr_b16 v[58:59], v16 offset:4608
    ds_read_b64_tr_b16 v[60:61], v17 offset:4096
    ds_read_b64_tr_b16 v[62:63], v17 offset:4608
    ds_read_b64_tr_b16 v[64:65], v16 offset:12288
    ds_read_b64_tr_b16 v[66:67], v16 offset:12800
    ds_read_b64_tr_b16 v[68:69], v17 offset:12288
    ds_read_b64_tr_b16 v[70:71], v17 offset:12800
    ds_read_b64_tr_b16 v[72:73], v16 offset:20480
    ds_read_b64_tr_b16 v[74:75], v16 offset:20992
    ds_read_b64_tr_b16 v[76:77], v17 offset:20480
    ds_read_b64_tr_b16 v[78:79], v17 offset:20992
    s_waitcnt lgkmcnt(0)
L_skip_59:
    s_setprio 2
    s_cmp_eq_u32 s51, 0
    s_cbranch_scc0 L_skip_60
    v_mov_b32 v128, -1
    v_mov_b32 v129, -1
    v_mov_b32 v130, -1
    v_mov_b32 v131, -1
    s_lshl_b32 s52, s49, 17
    s_lshl_b32 s61, s65, 16
    s_add_u32 s52, s52, s61
    s_lshl_b32 s61, s48, 11
    s_add_u32 s52, s52, s61
    s_add_u32 s52, s52, 0x800000
    buffer_store_dwordx4 v[128:131], v7, s[24:27], s52 offen sc1
    buffer_store_dwordx4 v[128:131], v7, s[24:27], s52 offen offset:1024 sc1
    s_add_u32 s52, s52, 32768
    buffer_store_dwordx4 v[128:131], v7, s[24:27], s52 offen sc1
    buffer_store_dwordx4 v[128:131], v7, s[24:27], s52 offen offset:1024 sc1
    s_mov_b64 exec, 0xff
    s_lshl_b32 s52, s49, 13
    s_lshl_b32 s61, s65, 12
    s_add_u32 s52, s52, s61
    s_lshl_b32 s61, s48, 7
    s_add_u32 s52, s52, s61
    s_add_u32 s52, s52, 0x600000
    buffer_store_dwordx4 v[128:131], v7, s[24:27], s52 offen sc1
    buffer_store_dwordx4 v[128:131], v7, s[24:27], s52 offen offset:2048 sc1
    s_lshl_b32 s52, s49, 12
    s_lshl_b32 s61, s65, 11
    s_add_u32 s52, s52, s61
    s_lshl_b32 s61, s48, 7
    s_add_u32 s52, s52, s61
    s_add_u32 s52, s52, 0x680000
    buffer_store_dwordx4 v[128:131], v7, s[24:27], s52 offen sc1
    s_lshl_b32 s52, s49, 8
    s_lshl_b32 s61, s65, 7
    s_add_u32 s52, s52, s61
    s_add_u32 s52, s52, 0x6c0000
    s_cmp_eq_u32 s48, s49
    s_cselect_b32 s52, s52, 1073741824
    buffer_store_dwordx4 v[128:131], v7, s[24:27], s52 offen sc1
    s_mov_b64 exec, -1
    v_lshrrev_b32 v3, 2, v1
    v_lshlrev_b32 v3, 10, v3
    v_and_or_b32 v3, v1, 3, v3
    s_lshl_b32 s52, s48, 6
    s_lshl_b32 s61, s49, 2
    s_add_u32 s52, s52, s61
    v_add_u32 v3, s52, v3
    s_cmp_eq_u32 s65, 0
    s_cselect_b32 s53, 2, 7
    s_cselect_b32 s52, 0, 7340032
    v_lshlrev_b32 v3, s53, v3
    v_mov_b32 v2, 0
    s_mov_b64 exec, 0xfffffff
    buffer_store_dword v2, v3, s[24:27], s52 offen sc1
    s_mov_b64 exec, -1
    s_lshl_b32 s52, s65, 2
    s_add_u32 s52, s52, 0x26b10
    v_mov_b32 v3, s52
    ds_write_b32 v3, v2
    s_lshl_b32 s52, s49, 14
    s_lshl_b32 s61, s48, 10
    s_add_u32 s52, s52, s61
    s_add_u32 s52, s52, 0x300000
    s_cmp_eq_u32 s65, 1
    s_cselect_b32 s52, s52, 1073741824
    buffer_store_dwordx4 v[128:131], v7, s[24:27], s52 offen sc1
    s_mov_b64 s[28:29], s[8:9]
    s_mov_b32 s30, 65536
    s_lshl_b32 s52, s49, 12
    s_lshl_b32 s61, s65, 11
    s_add_u32 s52, s52, s61
    s_lshl_b32 s53, s65, 11
    s_add_u32 m0, s53, 158720
    s_nop 0
    buffer_load_dwordx4 v7, s[28:31], s52 offen offset:0 lds
    buffer_load_dwordx4 v7, s[28:31], s52 offen offset:1024 lds
L_skip_60:
    s_bfe_u32 s66, s72, 0x40014
    s_mul_i32 s66, s66, 393216
    buffer_load_dword v20, v18, s[32:35], s66 offen
    s_setprio 0
    s_barrier
    s_cmp_eq_u32 s74, 1
    s_cbranch_scc0 L_skip_61
    ds_read_b64_tr_b16 v[32:33], v16 offset:0
    ds_read_b64_tr_b16 v[34:35], v16 offset:512
    ds_read_b64_tr_b16 v[36:37], v17 offset:0
    ds_read_b64_tr_b16 v[38:39], v17 offset:512
    ds_read_b64_tr_b16 v[40:41], v16 offset:8192
    ds_read_b64_tr_b16 v[42:43], v16 offset:8704
    ds_read_b64_tr_b16 v[44:45], v17 offset:8192
    ds_read_b64_tr_b16 v[46:47], v17 offset:8704
    ds_read_b64_tr_b16 v[48:49], v16 offset:16384
    ds_read_b64_tr_b16 v[50:51], v16 offset:16896
    ds_read_b64_tr_b16 v[52:53], v17 offset:16384
    ds_read_b64_tr_b16 v[54:55], v17 offset:16896
    ds_read_b64_tr_b16 v[56:57], v16 offset:4096
    ds_read_b64_tr_b16 v[58:59], v16 offset:4608
    ds_read_b64_tr_b16 v[60:61], v17 offset:4096
    ds_read_b64_tr_b16 v[62:63], v17 offset:4608
    ds_read_b64_tr_b16 v[64:65], v16 offset:12288
    ds_read_b64_tr_b16 v[66:67], v16 offset:12800
    ds_read_b64_tr_b16 v[68:69], v17 offset:12288
    ds_read_b64_tr_b16 v[70:71], v17 offset:12800
    ds_read_b64_tr_b16 v[72:73], v16 offset:20480
    ds_read_b64_tr_b16 v[74:75], v16 offset:20992
    ds_read_b64_tr_b16 v[76:77], v17 offset:20480
    ds_read_b64_tr_b16 v[78:79], v17 offset:20992
    s_waitcnt lgkmcnt(0)
L_skip_61:
    s_setprio 2
    s_bfe_u32 s66, s72, 0x40018
    s_mul_i32 s66, s66, 393216
    buffer_load_dword v20, v18, s[32:35], s66 offen
    s_setprio 0
    s_cmp_gt_u32 s91, 0
    s_cbranch_scc0 L_skip_62
    s_sub_u32 s52, s42, 512
    s_min_u32 s52, s52, s90
    s_buffer_load_dwordx2 s[88:89], s[40:43], s52 offset:60
    s_buffer_load_dwordx2 s[88:89], s[40:43], s52 offset:188
    s_buffer_load_dwordx2 s[88:89], s[40:43], s52 offset:316
    s_buffer_load_dwordx2 s[88:89], s[40:43], s52 offset:444
    s_add_u32 s90, s90, 512
L_skip_62:
    s_barrier
    s_cmp_eq_u32 s74, 2
    s_cbranch_scc0 L_skip_63
    ds_read_b64_tr_b16 v[32:33], v16 offset:0
    ds_read_b64_tr_b16 v[34:35], v16 offset:512
    ds_read_b64_tr_b16 v[36:37], v17 offset:0
    ds_read_b64_tr_b16 v[38:39], v17 offset:512
    ds_read_b64_tr_b16 v[40:41], v16 offset:8192
    ds_read_b64_tr_b16 v[42:43], v16 offset:8704
    ds_read_b64_tr_b16 v[44:45], v17 offset:8192
    ds_read_b64_tr_b16 v[46:47], v17 offset:8704
    ds_read_b64_tr_b16 v[48:49], v16 offset:16384
    ds_read_b64_tr_b16 v[50:51], v16 offset:16896
    ds_read_b64_tr_b16 v[52:53], v17 offset:16384
    ds_read_b64_tr_b16 v[54:55], v17 offset:16896
    ds_read_b64_tr_b16 v[56:57], v16 offset:4096
    ds_read_b64_tr_b16 v[58:59], v16 offset:4608
    ds_read_b64_tr_b16 v[60:61], v17 offset:4096
    ds_read_b64_tr_b16 v[62:63], v17 offset:4608
    ds_read_b64_tr_b16 v[64:65], v16 offset:12288
    ds_read_b64_tr_b16 v[66:67], v16 offset:12800
    ds_read_b64_tr_b16 v[68:69], v17 offset:12288
    ds_read_b64_tr_b16 v[70:71], v17 offset:12800
    ds_read_b64_tr_b16 v[72:73], v16 offset:20480
    ds_read_b64_tr_b16 v[74:75], v16 offset:20992
    ds_read_b64_tr_b16 v[76:77], v17 offset:20480
    ds_read_b64_tr_b16 v[78:79], v17 offset:20992
    s_waitcnt lgkmcnt(0)
L_skip_63:
    s_waitcnt vmcnt(0)
    s_setprio 2
    s_bfe_u32 s66, s72, 0x4001c
    s_mul_i32 s66, s66, 393216
    buffer_load_dword v20, v18, s[32:35], s66 offen
    s_setprio 0
    s_cmp_gt_u32 s91, 1
    s_cbranch_scc0 L_skip_64
    s_sub_u32 s52, s42, 512
    s_min_u32 s52, s52, s90
    s_buffer_load_dwordx2 s[88:89], s[40:43], s52 offset:60
    s_buffer_load_dwordx2 s[88:89], s[40:43], s52 offset:188
    s_buffer_load_dwordx2 s[88:89], s[40:43], s52 offset:316
    s_buffer_load_dwordx2 s[88:89], s[40:43], s52 offset:444
    s_add_u32 s90, s90, 512
L_skip_64:
    s_barrier
    s_cmp_eq_u32 s74, 3
    s_cbranch_scc0 L_skip_65
    ds_read_b64_tr_b16 v[32:33], v16 offset:0
    ds_read_b64_tr_b16 v[34:35], v16 offset:512
    ds_read_b64_tr_b16 v[36:37], v17 offset:0
    ds_read_b64_tr_b16 v[38:39], v17 offset:512
    ds_read_b64_tr_b16 v[40:41], v16 offset:8192
    ds_read_b64_tr_b16 v[42:43], v16 offset:8704
    ds_read_b64_tr_b16 v[44:45], v17 offset:8192
    ds_read_b64_tr_b16 v[46:47], v17 offset:8704
    ds_read_b64_tr_b16 v[48:49], v16 offset:16384
    ds_read_b64_tr_b16 v[50:51], v16 offset:16896
    ds_read_b64_tr_b16 v[52:53], v17 offset:16384
    ds_read_b64_tr_b16 v[54:55], v17 offset:16896
    ds_read_b64_tr_b16 v[56:57], v16 offset:4096
    ds_read_b64_tr_b16 v[58:59], v16 offset:4608
    ds_read_b64_tr_b16 v[60:61], v17 offset:4096
    ds_read_b64_tr_b16 v[62:63], v17 offset:4608
    ds_read_b64_tr_b16 v[64:65], v16 offset:12288
    ds_read_b64_tr_b16 v[66:67], v16 offset:12800
    ds_read_b64_tr_b16 v[68:69], v17 offset:12288
    ds_read_b64_tr_b16 v[70:71], v17 offset:12800
    ds_read_b64_tr_b16 v[72:73], v16 offset:20480
    ds_read_b64_tr_b16 v[74:75], v16 offset:20992
    ds_read_b64_tr_b16 v[76:77], v17 offset:20480
    ds_read_b64_tr_b16 v[78:79], v17 offset:20992
    s_waitcnt lgkmcnt(0)
L_skip_65:
    s_setprio 2
    s_or_b32 s52, s51, s65
    s_cmp_eq_u32 s52, 0
    s_cbranch_scc0 L_skip_66
    s_getreg_b32 s52, hwreg(HW_REG_XCC_ID, 0, 3)
    s_lshl_b32 s52, s52, 2
    s_lshl_b32 s53, 1, s52
    s_lshl_b32 s52, s48, 4
    s_add_u32 s52, s52, s95
    s_mov_b64 exec, 1
    v_mov_b32 v2, s53
    buffer_atomic_add v2, off, s[44:47], s52 sc1
    s_mov_b64 exec, -1
L_skip_66:
    s_bfe_u32 s66, s73, 0x40000
    s_mul_i32 s66, s66, 393216
    buffer_load_dword v20, v18, s[32:35], s66 offen
    s_setprio 0
    s_cmp_gt_u32 s91, 2
    s_cbranch_scc0 L_skip_67
    s_sub_u32 s52, s42, 512
    s_min_u32 s52, s52, s90
    s_buffer_load_dwordx2 s[88:89], s[40:43], s52 offset:60
    s_buffer_load_dwordx2 s[88:89], s[40:43], s52 offset:188
    s_buffer_load_dwordx2 s[88:89], s[40:43], s52 offset:316
    s_buffer_load_dwordx2 s[88:89], s[40:43], s52 offset:444
    s_add_u32 s90, s90, 512
L_skip_67:
    s_barrier
    s_cmp_eq_u32 s74, 4
    s_cbranch_scc0 L_skip_68
    ds_read_b64_tr_b16 v[32:33], v16 offset:0
    ds_read_b64_tr_b16 v[34:35], v16 offset:512
    ds_read_b64_tr_b16 v[36:37], v17 offset:0
    ds_read_b64_tr_b16 v[38:39], v17 offset:512
    ds_read_b64_tr_b16 v[40:41], v16 offset:8192
    ds_read_b64_tr_b16 v[42:43], v16 offset:8704
    ds_read_b64_tr_b16 v[44:45], v17 offset:8192
    ds_read_b64_tr_b16 v[46:47], v17 offset:8704
    ds_read_b64_tr_b16 v[48:49], v16 offset:16384
    ds_read_b64_tr_b16 v[50:51], v16 offset:16896
    ds_read_b64_tr_b16 v[52:53], v17 offset:16384
    ds_read_b64_tr_b16 v[54:55], v17 offset:16896
    ds_read_b64_tr_b16 v[56:57], v16 offset:4096
    ds_read_b64_tr_b16 v[58:59], v16 offset:4608
    ds_read_b64_tr_b16 v[60:61], v17 offset:4096
    ds_read_b64_tr_b16 v[62:63], v17 offset:4608
    ds_read_b64_tr_b16 v[64:65], v16 offset:12288
    ds_read_b64_tr_b16 v[66:67], v16 offset:12800
    ds_read_b64_tr_b16 v[68:69], v17 offset:12288
    ds_read_b64_tr_b16 v[70:71], v17 offset:12800
    ds_read_b64_tr_b16 v[72:73], v16 offset:20480
    ds_read_b64_tr_b16 v[74:75], v16 offset:20992
    ds_read_b64_tr_b16 v[76:77], v17 offset:20480
    ds_read_b64_tr_b16 v[78:79], v17 offset:20992
    s_waitcnt lgkmcnt(0)
L_skip_68:
    s_setprio 2
    s_cmp_eq_u32 s51, 0
    s_cbranch_scc0 L_skip_69
    v_mfma_f32_16x16x32_bf16 v[96:99], v[8:11], v[32:35], 0
    v_mfma_f32_16x16x32_bf16 v[100:103], v[8:11], v[36:39], 0
    v_mfma_f32_16x16x32_bf16 v[104:107], v[8:11], v[40:43], 0
    v_mfma_f32_16x16x32_bf16 v[108:111], v[8:11], v[44:47], 0
    v_mfma_f32_16x16x32_bf16 v[112:115], v[8:11], v[48:51], 0
    v_mfma_f32_16x16x32_bf16 v[116:119], v[8:11], v[52:55], 0
    v_mfma_f32_16x16x32_bf16 v[96:99], v[8:11], v[56:59], v[96:99]
    v_mfma_f32_16x16x32_bf16 v[100:103], v[8:11], v[60:63], v[100:103]
    v_mfma_f32_16x16x32_bf16 v[104:107], v[8:11], v[64:67], v[104:107]
    v_mfma_f32_16x16x32_bf16 v[108:111], v[8:11], v[68:71], v[108:111]
    v_mfma_f32_16x16x32_bf16 v[112:115], v[8:11], v[72:75], v[112:115]
    v_mfma_f32_16x16x32_bf16 v[116:119], v[8:11], v[76:79], v[116:119]
    s_lshl_b32 s52, s51, 18
    s_lshl_b32 s61, s49, 14
    s_add_u32 s52, s52, s61
    s_lshl_b32 s61, s48, 10
    s_add_u32 s52, s52, s61
    s_lshl_b32 s61, s65, 7
    s_add_u32 s52, s52, s61
    s_add_u32 s52, s52, 0x300000
    s_mov_b64 exec, 0xffff
    buffer_store_dword v96, v6, s[24:27], s52 offen offset:0 sc1
    buffer_store_dword v100, v6, s[24:27], s52 offen offset:64 sc1
    buffer_store_dword v104, v6, s[24:27], s52 offen offset:256 sc1
    buffer_store_dword v108, v6, s[24:27], s52 offen offset:320 sc1
    buffer_store_dword v112, v6, s[24:27], s52 offen offset:512 sc1
    buffer_store_dword v116, v6, s[24:27], s52 offen offset:576 sc1
    s_mov_b64 exec, -1
L_skip_69:
    s_cmp_lg_u32 s51, 0
    s_cbranch_scc0 L_skip_70
    buffer_load_dword v22, v21, s[24:27], s70 offen sc1
L_skip_70:
    s_bfe_u32 s66, s73, 0x40004
    s_mul_i32 s66, s66, 393216
    buffer_load_dword v20, v18, s[32:35], s66 offen
    s_setprio 0
    s_cmp_gt_u32 s91, 3
    s_cbranch_scc0 L_skip_71
    s_sub_u32 s52, s42, 512
    s_min_u32 s52, s52, s90
    s_buffer_load_dwordx2 s[88:89], s[40:43], s52 offset:60
    s_buffer_load_dwordx2 s[88:89], s[40:43], s52 offset:188
    s_buffer_load_dwordx2 s[88:89], s[40:43], s52 offset:316
    s_buffer_load_dwordx2 s[88:89], s[40:43], s52 offset:444
    s_add_u32 s90, s90, 512
L_skip_71:
    s_barrier
    s_cmp_eq_u32 s74, 5
    s_cbranch_scc0 L_skip_72
    ds_read_b64_tr_b16 v[32:33], v16 offset:0
    ds_read_b64_tr_b16 v[34:35], v16 offset:512
    ds_read_b64_tr_b16 v[36:37], v17 offset:0
    ds_read_b64_tr_b16 v[38:39], v17 offset:512
    ds_read_b64_tr_b16 v[40:41], v16 offset:8192
    ds_read_b64_tr_b16 v[42:43], v16 offset:8704
    ds_read_b64_tr_b16 v[44:45], v17 offset:8192
    ds_read_b64_tr_b16 v[46:47], v17 offset:8704
    ds_read_b64_tr_b16 v[48:49], v16 offset:16384
    ds_read_b64_tr_b16 v[50:51], v16 offset:16896
    ds_read_b64_tr_b16 v[52:53], v17 offset:16384
    ds_read_b64_tr_b16 v[54:55], v17 offset:16896
    ds_read_b64_tr_b16 v[56:57], v16 offset:4096
    ds_read_b64_tr_b16 v[58:59], v16 offset:4608
    ds_read_b64_tr_b16 v[60:61], v17 offset:4096
    ds_read_b64_tr_b16 v[62:63], v17 offset:4608
    ds_read_b64_tr_b16 v[64:65], v16 offset:12288
    ds_read_b64_tr_b16 v[66:67], v16 offset:12800
    ds_read_b64_tr_b16 v[68:69], v17 offset:12288
    ds_read_b64_tr_b16 v[70:71], v17 offset:12800
    ds_read_b64_tr_b16 v[72:73], v16 offset:20480
    ds_read_b64_tr_b16 v[74:75], v16 offset:20992
    ds_read_b64_tr_b16 v[76:77], v17 offset:20480
    ds_read_b64_tr_b16 v[78:79], v17 offset:20992
    s_waitcnt lgkmcnt(0)
L_skip_72:
    s_waitcnt vmcnt(0)
    s_cmp_lg_u32 s51, 0
    s_cbranch_scc0 L_skip_73
    s_mov_b32 s60, 0
    s_branch L_chk_75
L_spin_74:
    s_sleep 1
    buffer_load_dword v22, v21, s[24:27], s70 offen sc1
    s_add_u32 s60, s60, 1
    s_cmp_lt_u32 s60, 300000
    s_cbranch_scc0 L_tmo_76
    s_waitcnt vmcnt(0)
L_chk_75:
    v_cmp_eq_u32 vcc, 0, v22
    s_cbranch_vccnz L_spin_74
L_done_78:
L_skip_73:
    s_setprio 2
    s_bfe_u32 s66, s73, 0x40008
    s_mul_i32 s66, s66, 393216
    buffer_load_dword v20, v18, s[32:35], s66 offen
    s_cmp_eq_u32 s51, 0
    s_cbranch_scc0 L_skip_79
    s_mov_b32 s66, 0
    buffer_load_dword v20, v19, s[36:39], s66 offen
L_skip_79:
    s_setprio 0
    s_cmp_gt_u32 s91, 4
    s_cbranch_scc0 L_skip_80
    s_mov_b64 s[40:41], s[14:15]
    s_mov_b32 s42, 6291456
    s_mul_i32 s90, s2, 24576
    s_mul_i32 s61, s50, 6144
    s_add_u32 s90, s90, s61
    s_sub_u32 s90, s90, 0x6000
    s_sub_u32 s52, s42, 512
    s_min_u32 s52, s52, s90
    s_buffer_load_dwordx2 s[88:89], s[40:43], s52 offset:60
    s_buffer_load_dwordx2 s[88:89], s[40:43], s52 offset:188
    s_buffer_load_dwordx2 s[88:89], s[40:43], s52 offset:316
    s_buffer_load_dwordx2 s[88:89], s[40:43], s52 offset:444
    s_add_u32 s90, s90, 512
L_skip_80:
    s_cmp_lg_u32 s71, -1
    s_cbranch_scc0 L_skip_81
    s_buffer_load_dwordx2 s[88:89], s[36:39], s71 offset:60
    s_buffer_load_dwordx2 s[88:89], s[36:39], s71 offset:2108
    s_buffer_load_dwordx2 s[88:89], s[36:39], s71 offset:4156
    s_buffer_load_dwordx2 s[88:89], s[36:39], s71 offset:6204
L_skip_81:
    s_barrier
    s_cmp_eq_u32 s74, 6
    s_cbranch_scc0 L_skip_82
    ds_read_b64_tr_b16 v[32:33], v16 offset:0
    ds_read_b64_tr_b16 v[34:35], v16 offset:512
    ds_read_b64_tr_b16 v[36:37], v17 offset:0
    ds_read_b64_tr_b16 v[38:39], v17 offset:512
    ds_read_b64_tr_b16 v[40:41], v16 offset:8192
    ds_read_b64_tr_b16 v[42:43], v16 offset:8704
    ds_read_b64_tr_b16 v[44:45], v17 offset:8192
    ds_read_b64_tr_b16 v[46:47], v17 offset:8704
    ds_read_b64_tr_b16 v[48:49], v16 offset:16384
    ds_read_b64_tr_b16 v[50:51], v16 offset:16896
    ds_read_b64_tr_b16 v[52:53], v17 offset:16384
    ds_read_b64_tr_b16 v[54:55], v17 offset:16896
    ds_read_b64_tr_b16 v[56:57], v16 offset:4096
    ds_read_b64_tr_b16 v[58:59], v16 offset:4608
    ds_read_b64_tr_b16 v[60:61], v17 offset:4096
    ds_read_b64_tr_b16 v[62:63], v17 offset:4608
    ds_read_b64_tr_b16 v[64:65], v16 offset:12288
    ds_read_b64_tr_b16 v[66:67], v16 offset:12800
    ds_read_b64_tr_b16 v[68:69], v17 offset:12288
    ds_read_b64_tr_b16 v[70:71], v17 offset:12800
    ds_read_b64_tr_b16 v[72:73], v16 offset:20480
    ds_read_b64_tr_b16 v[74:75], v16 offset:20992
    ds_read_b64_tr_b16 v[76:77], v17 offset:20480
    ds_read_b64_tr_b16 v[78:79], v17 offset:20992
    s_waitcnt lgkmcnt(0)
L_skip_82:
    s_setprio 2
    s_bfe_u32 s66, s73, 0x4000c
    s_mul_i32 s66, s66, 393216
    buffer_load_dword v20, v18, s[32:35], s66 offen
    s_cmp_eq_u32 s51, 0
    s_cbranch_scc0 L_skip_83
    s_mov_b32 s66, 16384
    buffer_load_dword v20, v19, s[36:39], s66 offen
L_skip_83:
    s_cmp_eq_u32 s51, 2
    s_cbranch_scc0 L_skip_84
    s_mov_b64 s[28:29], s[8:9]
    s_mov_b32 s30, 65536
    s_lshl_b32 s52, s49, 12
    s_lshl_b32 s61, s65, 11
    s_add_u32 s52, s52, s61
    s_lshl_b32 s53, s65, 11
    s_add_u32 m0, s53, 158720
    s_nop 0
    buffer_load_dwordx4 v7, s[28:31], s52 offen offset:0 lds
    buffer_load_dwordx4 v7, s[28:31], s52 offen offset:1024 lds
L_skip_84:
    s_setprio 0
    s_cmp_gt_u32 s91, 5
    s_cbranch_scc0 L_skip_85
    s_sub_u32 s52, s42, 512
    s_min_u32 s52, s52, s90
    s_buffer_load_dwordx2 s[88:89], s[40:43], s52 offset:60
    s_buffer_load_dwordx2 s[88:89], s[40:43], s52 offset:188
    s_buffer_load_dwordx2 s[88:89], s[40:43], s52 offset:316
    s_buffer_load_dwordx2 s[88:89], s[40:43], s52 offset:444
    s_add_u32 s90, s90, 512
L_skip_85:
    s_cmp_lg_u32 s71, -1
    s_cbranch_scc0 L_skip_86
    s_buffer_load_dwordx2 s[88:89], s[36:39], s71 offset:8252
    s_buffer_load_dwordx2 s[88:89], s[36:39], s71 offset:10300
    s_buffer_load_dwordx2 s[88:89], s[36:39], s71 offset:12348
    s_buffer_load_dwordx2 s[88:89], s[36:39], s71 offset:14396
L_skip_86:
    s_barrier
    s_cmp_eq_u32 s74, 7
    s_cbranch_scc0 L_skip_87
    ds_read_b64_tr_b16 v[32:33], v16 offset:0
    ds_read_b64_tr_b16 v[34:35], v16 offset:512
    ds_read_b64_tr_b16 v[36:37], v17 offset:0
    ds_read_b64_tr_b16 v[38:39], v17 offset:512
    ds_read_b64_tr_b16 v[40:41], v16 offset:8192
    ds_read_b64_tr_b16 v[42:43], v16 offset:8704
    ds_read_b64_tr_b16 v[44:45], v17 offset:8192
    ds_read_b64_tr_b16 v[46:47], v17 offset:8704
    ds_read_b64_tr_b16 v[48:49], v16 offset:16384
    ds_read_b64_tr_b16 v[50:51], v16 offset:16896
    ds_read_b64_tr_b16 v[52:53], v17 offset:16384
    ds_read_b64_tr_b16 v[54:55], v17 offset:16896
    ds_read_b64_tr_b16 v[56:57], v16 offset:4096
    ds_read_b64_tr_b16 v[58:59], v16 offset:4608
    ds_read_b64_tr_b16 v[60:61], v17 offset:4096
    ds_read_b64_tr_b16 v[62:63], v17 offset:4608
    ds_read_b64_tr_b16 v[64:65], v16 offset:12288
    ds_read_b64_tr_b16 v[66:67], v16 offset:12800
    ds_read_b64_tr_b16 v[68:69], v17 offset:12288
    ds_read_b64_tr_b16 v[70:71], v17 offset:12800
    ds_read_b64_tr_b16 v[72:73], v16 offset:20480
    ds_read_b64_tr_b16 v[74:75], v16 offset:20992
    ds_read_b64_tr_b16 v[76:77], v17 offset:20480
    ds_read_b64_tr_b16 v[78:79], v17 offset:20992
    s_waitcnt lgkmcnt(0)
L_skip_87:
    s_setprio 2
    s_bfe_u32 s66, s73, 0x40010
    s_mul_i32 s66, s66, 393216
    buffer_load_dword v20, v18, s[32:35], s66 offen
    s_cmp_eq_u32 s51, 0
    s_cbranch_scc0 L_skip_88
    s_mov_b32 s66, 32768
    buffer_load_dword v20, v19, s[36:39], s66 offen
L_skip_88:
    s_setprio 0
    s_cmp_gt_u32 s91, 6
    s_cbranch_scc0 L_skip_89
    s_sub_u32 s52, s42, 512
    s_min_u32 s52, s52, s90
    s_buffer_load_dwordx2 s[88:89], s[40:43], s52 offset:60
    s_buffer_load_dwordx2 s[88:89], s[40:43], s52 offset:188
    s_buffer_load_dwordx2 s[88:89], s[40:43], s52 offset:316
    s_buffer_load_dwordx2 s[88:89], s[40:43], s52 offset:444
    s_add_u32 s90, s90, 512
L_skip_89:
    s_cmp_lg_u32 s71, -1
    s_cbranch_scc0 L_skip_90
    s_buffer_load_dwordx2 s[88:89], s[36:39], s71 offset:16444
    s_buffer_load_dwordx2 s[88:89], s[36:39], s71 offset:18492
    s_buffer_load_dwordx2 s[88:89], s[36:39], s71 offset:20540
    s_buffer_load_dwordx2 s[88:89], s[36:39], s71 offset:22588
L_skip_90:
    s_barrier
    s_cmp_eq_u32 s74, 8
    s_cbranch_scc0 L_skip_91
    ds_read_b64_tr_b16 v[32:33], v16 offset:0
    ds_read_b64_tr_b16 v[34:35], v16 offset:512
    ds_read_b64_tr_b16 v[36:37], v17 offset:0
    ds_read_b64_tr_b16 v[38:39], v17 offset:512
    ds_read_b64_tr_b16 v[40:41], v16 offset:8192
    ds_read_b64_tr_b16 v[42:43], v16 offset:8704
    ds_read_b64_tr_b16 v[44:45], v17 offset:8192
    ds_read_b64_tr_b16 v[46:47], v17 offset:8704
    ds_read_b64_tr_b16 v[48:49], v16 offset:16384
    ds_read_b64_tr_b16 v[50:51], v16 offset:16896
    ds_read_b64_tr_b16 v[52:53], v17 offset:16384
    ds_read_b64_tr_b16 v[54:55], v17 offset:16896
    ds_read_b64_tr_b16 v[56:57], v16 offset:4096
    ds_read_b64_tr_b16 v[58:59], v16 offset:4608
    ds_read_b64_tr_b16 v[60:61], v17 offset:4096
    ds_read_b64_tr_b16 v[62:63], v17 offset:4608
    ds_read_b64_tr_b16 v[64:65], v16 offset:12288
    ds_read_b64_tr_b16 v[66:67], v16 offset:12800
    ds_read_b64_tr_b16 v[68:69], v17 offset:12288
    ds_read_b64_tr_b16 v[70:71], v17 offset:12800
    ds_read_b64_tr_b16 v[72:73], v16 offset:20480
    ds_read_b64_tr_b16 v[74:75], v16 offset:20992
    ds_read_b64_tr_b16 v[76:77], v17 offset:20480
    ds_read_b64_tr_b16 v[78:79], v17 offset:20992
    s_waitcnt lgkmcnt(0)
L_skip_91:
    s_setprio 2
    s_or_b32 s52, s51, s65
    s_cmp_eq_u32 s52, 0
    s_cbranch_scc0 L_skip_92
    v_and_b32 v4, 31, v1
    v_lshlrev_b32 v4, 3, v4
    buffer_load_dword v22, v4, s[44:47], 0 offen sc1
L_skip_92:
    s_bfe_u32 s66, s73, 0x40014
    s_mul_i32 s66, s66, 393216
    buffer_load_dword v20, v18, s[32:35], s66 offen
    s_cmp_eq_u32 s51, 0
    s_cbranch_scc0 L_skip_93
    s_mov_b32 s66, 49152
    buffer_load_dword v20, v19, s[36:39], s66 offen
L_skip_93:
    s_setprio 0
    s_cmp_gt_u32 s91, 7
    s_cbranch_scc0 L_skip_94
    s_sub_u32 s52, s42, 512
    s_min_u32 s52, s52, s90
    s_buffer_load_dwordx2 s[88:89], s[40:43], s52 offset:60
    s_buffer_load_dwordx2 s[88:89], s[40:43], s52 offset:188
    s_buffer_load_dwordx2 s[88:89], s[40:43], s52 offset:316
    s_buffer_load_dwordx2 s[88:89], s[40:43], s52 offset:444
    s_add_u32 s90, s90, 512
L_skip_94:
    s_cmp_lg_u32 s71, -1
    s_cbranch_scc0 L_skip_95
    s_buffer_load_dwordx2 s[88:89], s[36:39], s71 offset:24636
    s_buffer_load_dwordx2 s[88:89], s[36:39], s71 offset:26684
    s_buffer_load_dwordx2 s[88:89], s[36:39], s71 offset:28732
    s_buffer_load_dwordx2 s[88:89], s[36:39], s71 offset:30780
L_skip_95:
    s_barrier
    s_cmp_eq_u32 s74, 9
    s_cbranch_scc0 L_skip_96
    ds_read_b64_tr_b16 v[32:33], v16 offset:0
    ds_read_b64_tr_b16 v[34:35], v16 offset:512
    ds_read_b64_tr_b16 v[36:37], v17 offset:0
    ds_read_b64_tr_b16 v[38:39], v17 offset:512
    ds_read_b64_tr_b16 v[40:41], v16 offset:8192
    ds_read_b64_tr_b16 v[42:43], v16 offset:8704
    ds_read_b64_tr_b16 v[44:45], v17 offset:8192
    ds_read_b64_tr_b16 v[46:47], v17 offset:8704
    ds_read_b64_tr_b16 v[48:49], v16 offset:16384
    ds_read_b64_tr_b16 v[50:51], v16 offset:16896
    ds_read_b64_tr_b16 v[52:53], v17 offset:16384
    ds_read_b64_tr_b16 v[54:55], v17 offset:16896
    ds_read_b64_tr_b16 v[56:57], v16 offset:4096
    ds_read_b64_tr_b16 v[58:59], v16 offset:4608
    ds_read_b64_tr_b16 v[60:61], v17 offset:4096
    ds_read_b64_tr_b16 v[62:63], v17 offset:4608
    ds_read_b64_tr_b16 v[64:65], v16 offset:12288
    ds_read_b64_tr_b16 v[66:67], v16 offset:12800
    ds_read_b64_tr_b16 v[68:69], v17 offset:12288
    ds_read_b64_tr_b16 v[70:71], v17 offset:12800
    ds_read_b64_tr_b16 v[72:73], v16 offset:20480
    ds_read_b64_tr_b16 v[74:75], v16 offset:20992
    ds_read_b64_tr_b16 v[76:77], v17 offset:20480
    ds_read_b64_tr_b16 v[78:79], v17 offset:20992
    s_waitcnt lgkmcnt(0)
L_skip_96:
    s_or_b32 s52, s51, s65
    s_cmp_eq_u32 s52, 0
    s_cbranch_scc0 L_skip_97
    s_waitcnt vmcnt(0)
    s_mov_b32 s60, 0
    s_branch L_chk_99
L_spin_98:
    s_sleep 16
    buffer_load_dword v22, v4, s[44:47], 0 offen sc1
    s_add_u32 s60, s60, 1
    s_cmp_lt_u32 s60, 300000
    s_cbranch_scc0 L_tmo_100
    s_waitcnt vmcnt(0)
L_chk_99:
    v_lshrrev_b32 v3, 4, v22
    v_and_b32 v3, 0x0f0f0f0f, v3
    v_and_b32 v5, 0x0f0f0f0f, v22
    v_sad_u8 v3, v3, 0, 0
    v_sad_u8 v5, v5, 0, v3
    v_cmp_gt_u32 vcc, 8, v5
    s_cbranch_vccnz L_spin_98
L_done_102:
    s_lshr_b32 s52, s95, 3
    s_lshl_b32 s53, s48, 1
    s_add_u32 s52, s52, s53
    v_readlane_b32 s3, v22, s52
    s_nop 0
    s_and_b32 s3, s3, 0x88888888
    s_cselect_b32 s3, 1, 0
    v_mov_b32 v5, s3
    v_mov_b32 v4, 158464
    ds_write_b32 v4, v5
L_skip_97:
    s_setprio 2
    s_bfe_u32 s66, s73, 0x40018
    s_mul_i32 s66, s66, 393216
    buffer_load_dword v20, v18, s[32:35], s66 offen
    s_setprio 0
    s_cmp_gt_u32 s91, 8
    s_cbranch_scc0 L_skip_103
    s_sub_u32 s52, s42, 512
    s_min_u32 s52, s52, s90
    s_buffer_load_dwordx2 s[88:89], s[40:43], s52 offset:60
    s_buffer_load_dwordx2 s[88:89], s[40:43], s52 offset:188
    s_buffer_load_dwordx2 s[88:89], s[40:43], s52 offset:316
    s_buffer_load_dwordx2 s[88:89], s[40:43], s52 offset:444
    s_add_u32 s90, s90, 512
L_skip_103:
    s_cmp_lg_u32 s71, -1
    s_cbranch_scc0 L_skip_104
    s_buffer_load_dwordx2 s[88:89], s[36:39], s71 offset:32828
    s_buffer_load_dwordx2 s[88:89], s[36:39], s71 offset:34876
    s_buffer_load_dwordx2 s[88:89], s[36:39], s71 offset:36924
    s_buffer_load_dwordx2 s[88:89], s[36:39], s71 offset:38972
L_skip_104:
    s_barrier
    s_setprio 2
    s_cmp_eq_u32 s51, 1
    s_cbranch_scc0 L_skip_105
    v_mfma_f32_16x16x32_bf16 v[96:99], v[8:11], v[32:35], 0
    v_mfma_f32_16x16x32_bf16 v[100:103], v[8:11], v[36:39], 0
    v_mfma_f32_16x16x32_bf16 v[104:107], v[8:11], v[40:43], 0
    v_mfma_f32_16x16x32_bf16 v[108:111], v[8:11], v[44:47], 0
    v_mfma_f32_16x16x32_bf16 v[112:115], v[8:11], v[48:51], 0
    v_mfma_f32_16x16x32_bf16 v[116:119], v[8:11], v[52:55], 0
    v_mfma_f32_16x16x32_bf16 v[96:99], v[8:11], v[56:59], v[96:99]
    v_mfma_f32_16x16x32_bf16 v[100:103], v[8:11], v[60:63], v[100:103]
    v_mfma_f32_16x16x32_bf16 v[104:107], v[8:11], v[64:67], v[104:107]
    v_mfma_f32_16x16x32_bf16 v[108:111], v[8:11], v[68:71], v[108:111]
    v_mfma_f32_16x16x32_bf16 v[112:115], v[8:11], v[72:75], v[112:115]
    v_mfma_f32_16x16x32_bf16 v[116:119], v[8:11], v[76:79], v[116:119]
    s_lshl_b32 s52, s51, 18
    s_lshl_b32 s61, s49, 14
    s_add_u32 s52, s52, s61
    s_lshl_b32 s61, s48, 10
    s_add_u32 s52, s52, s61
    s_lshl_b32 s61, s65, 7
    s_add_u32 s52, s52, s61
    s_add_u32 s52, s52, 0x300000
    s_mov_b64 exec, 0xffff
    buffer_store_dword v96, v6, s[24:27], s52 offen offset:0 sc1
    buffer_store_dword v100, v6, s[24:27], s52 offen offset:64 sc1
    buffer_store_dword v104, v6, s[24:27], s52 offen offset:256 sc1
    buffer_store_dword v108, v6, s[24:27], s52 offen offset:320 sc1
    buffer_store_dword v112, v6, s[24:27], s52 offen offset:512 sc1
    buffer_store_dword v116, v6, s[24:27], s52 offen offset:576 sc1
    s_mov_b64 exec, -1
L_skip_105:
    s_bfe_u32 s66, s73, 0x4001c
    s_mul_i32 s66, s66, 393216
    buffer_load_dword v20, v18, s[32:35], s66 offen
    s_add_u32 s52, s67, 0
    buffer_load_dwordx4 v[128:131], v14, s[24:27], s52 offen offset:0 sc1
    s_add_u32 s52, s67, 0
    buffer_load_dwordx4 v[132:135], v14, s[24:27], s52 offen offset:2048 sc1
    s_add_u32 s52, s67, 4096
    buffer_load_dwordx4 v[136:139], v14, s[24:27], s52 offen offset:0 sc1
    s_add_u32 s52, s67, 4096
    buffer_load_dwordx4 v[140:143], v14, s[24:27], s52 offen offset:2048 sc1
    s_setprio 0
    s_cmp_gt_u32 s91, 9
    s_cbranch_scc0 L_skip_106
    s_sub_u32 s52, s42, 512
    s_min_u32 s52, s52, s90
    s_buffer_load_dwordx2 s[88:89], s[40:43], s52 offset:60
    s_buffer_load_dwordx2 s[88:89], s[40:43], s52 offset:188
    s_buffer_load_dwordx2 s[88:89], s[40:43], s52 offset:316
    s_buffer_load_dwordx2 s[88:89], s[40:43], s52 offset:444
    s_add_u32 s90, s90, 512
L_skip_106:
    s_cmp_lg_u32 s71, -1
    s_cbranch_scc0 L_skip_107
    s_buffer_load_dwordx2 s[88:89], s[36:39], s71 offset:41020
    s_buffer_load_dwordx2 s[88:89], s[36:39], s71 offset:43068
    s_buffer_load_dwordx2 s[88:89], s[36:39], s71 offset:45116
    s_buffer_load_dwordx2 s[88:89], s[36:39], s71 offset:47164
L_skip_107:
    s_barrier
    s_setprio 2
    s_add_u32 s52, s67, 8192
    buffer_load_dwordx4 v[144:147], v14, s[24:27], s52 offen offset:0 sc1
    s_add_u32 s52, s67, 8192
    buffer_load_dwordx4 v[148:151], v14, s[24:27], s52 offen offset:2048 sc1
    s_add_u32 s52, s67, 12288
    buffer_load_dwordx4 v[152:155], v14, s[24:27], s52 offen offset:0 sc1
    s_add_u32 s52, s67, 12288
    buffer_load_dwordx4 v[156:159], v14, s[24:27], s52 offen offset:2048 sc1
    s_cmp_lt_u32 s51, 2
    s_cbranch_scc0 L_skip_108
    s_add_u32 s52, s68, 0
    buffer_load_dwordx4 v[160:163], v15, s[24:27], s52 offen offset:0 sc1
    s_add_u32 s52, s68, 0
    buffer_load_dwordx4 v[164:167], v15, s[24:27], s52 offen offset:2048 sc1
    s_add_u32 s52, s68, 4096
    buffer_load_dwordx4 v[168:171], v15, s[24:27], s52 offen offset:0 sc1
    s_add_u32 s52, s68, 4096
    buffer_load_dwordx4 v[172:175], v15, s[24:27], s52 offen offset:2048 sc1
L_skip_108:
    s_setprio 0
    s_cmp_gt_u32 s91, 10
    s_cbranch_scc0 L_skip_109
    s_sub_u32 s52, s42, 512
    s_min_u32 s52, s52, s90
    s_buffer_load_dwordx2 s[88:89], s[40:43], s52 offset:60
    s_buffer_load_dwordx2 s[88:89], s[40:43], s52 offset:188
    s_buffer_load_dwordx2 s[88:89], s[40:43], s52 offset:316
    s_buffer_load_dwordx2 s[88:89], s[40:43], s52 offset:444
    s_add_u32 s90, s90, 512
L_skip_109:
    s_cmp_lg_u32 s71, -1
    s_cbranch_scc0 L_skip_110
    s_buffer_load_dwordx2 s[88:89], s[36:39], s71 offset:49212
    s_buffer_load_dwordx2 s[88:89], s[36:39], s71 offset:51260
    s_buffer_load_dwordx2 s[88:89], s[36:39], s71 offset:53308
    s_buffer_load_dwordx2 s[88:89], s[36:39], s71 offset:55356
L_skip_110:
    s_barrier
    s_setprio 2
    s_cmp_lt_u32 s51, 2
    s_cbranch_scc0 L_skip_111
    s_add_u32 s52, s68, 8192
    buffer_load_dwordx4 v[176:179], v15, s[24:27], s52 offen offset:0 sc1
    s_add_u32 s52, s68, 8192
    buffer_load_dwordx4 v[180:183], v15, s[24:27], s52 offen offset:2048 sc1
    s_add_u32 s52, s68, 12288
    buffer_load_dwordx4 v[184:187], v15, s[24:27], s52 offen offset:0 sc1
    s_add_u32 s52, s68, 12288
    buffer_load_dwordx4 v[188:191], v15, s[24:27], s52 offen offset:2048 sc1
L_skip_111:
    s_setprio 0
    s_cmp_gt_u32 s91, 11
    s_cbranch_scc0 L_skip_112
    s_sub_u32 s52, s42, 512
    s_min_u32 s52, s52, s90
    s_buffer_load_dwordx2 s[88:89], s[40:43], s52 offset:60
    s_buffer_load_dwordx2 s[88:89], s[40:43], s52 offset:188
    s_buffer_load_dwordx2 s[88:89], s[40:43], s52 offset:316
    s_buffer_load_dwordx2 s[88:89], s[40:43], s52 offset:444
    s_add_u32 s90, s90, 512
L_skip_112:
    s_cmp_lg_u32 s71, -1
    s_cbranch_scc0 L_skip_113
    s_buffer_load_dwordx2 s[88:89], s[36:39], s71 offset:57404
    s_buffer_load_dwordx2 s[88:89], s[36:39], s71 offset:59452
    s_buffer_load_dwordx2 s[88:89], s[36:39], s71 offset:61500
    s_buffer_load_dwordx2 s[88:89], s[36:39], s71 offset:63548
L_skip_113:
    s_barrier
    s_waitcnt vmcnt(0)
    s_setprio 2
    s_setprio 0
    s_mov_b32 s60, 0
    s_branch L_chk_115
L_spin_114:
    s_add_u32 s52, s67, 0
    buffer_load_dwordx4 v[128:131], v14, s[24:27], s52 offen offset:0 sc1
    s_add_u32 s52, s67, 0
    buffer_load_dwordx4 v[132:135], v14, s[24:27], s52 offen offset:2048 sc1
    s_add_u32 s52, s67, 4096
    buffer_load_dwordx4 v[136:139], v14, s[24:27], s52 offen offset:0 sc1
    s_add_u32 s52, s67, 4096
    buffer_load_dwordx4 v[140:143], v14, s[24:27], s52 offen offset:2048 sc1
    s_add_u32 s52, s67, 8192
    buffer_load_dwordx4 v[144:147], v14, s[24:27], s52 offen offset:0 sc1
    s_add_u32 s52, s67, 8192
    buffer_load_dwordx4 v[148:151], v14, s[24:27], s52 offen offset:2048 sc1
    s_add_u32 s52, s67, 12288
    buffer_load_dwordx4 v[152:155], v14, s[24:27], s52 offen offset:0 sc1
    s_add_u32 s52, s67, 12288
    buffer_load_dwordx4 v[156:159], v14, s[24:27], s52 offen offset:2048 sc1
    s_add_u32 s60, s60, 1
    s_cmp_lt_u32 s60, 300000
    s_cbranch_scc0 L_tmo_116
    s_waitcnt vmcnt(0)
L_chk_115:
    v_max_u32 v2, v128, v129
    v_max3_u32 v2, v2, v130, v131
    v_max3_u32 v2, v2, v132, v133
    v_max3_u32 v2, v2, v134, v135
    v_max3_u32 v2, v2, v136, v137
    v_max3_u32 v2, v2, v138, v139
    v_max3_u32 v2, v2, v140, v141
    v_max3_u32 v2, v2, v142, v143
    v_max_u32 v3, v144, v145
    v_max3_u32 v3, v3, v146, v147
    v_max3_u32 v3, v3, v148, v149
    v_max3_u32 v3, v3, v150, v151
    v_max3_u32 v3, v3, v152, v153
    v_max3_u32 v3, v3, v154, v155
    v_max3_u32 v3, v3, v156, v157
    v_max3_u32 v3, v3, v158, v159
    v_max_u32 v2, v2, v3
    v_cmp_eq_u32 vcc, -1, v2
    s_cbranch_vccnz L_spin_114
L_done_118:
    v_add_f32 v128, v128, v144
    v_add_f32 v129, v129, v145
    v_add_f32 v130, v130, v146
    v_add_f32 v131, v131, v147
    v_add_f32 v132, v132, v148
    v_add_f32 v133, v133, v149
    v_add_f32 v134, v134, v150
    v_add_f32 v135, v135, v151
    v_add_f32 v136, v136, v152
    v_add_f32 v137, v137, v153
    v_add_f32 v138, v138, v154
    v_add_f32 v139, v139, v155
    v_add_f32 v140, v140, v156
    v_add_f32 v141, v141, v157
    v_add_f32 v142, v142, v158
    v_add_f32 v143, v143, v159
    v_add_f32 v128, v128, v136
    v_add_f32 v129, v129, v137
    v_add_f32 v130, v130, v138
    v_add_f32 v131, v131, v139
    v_add_f32 v132, v132, v140
    v_add_f32 v133, v133, v141
    v_add_f32 v134, v134, v142
    v_add_f32 v135, v135, v143
    v_add_f32 v128, v128, v132
    v_add_f32 v129, v129, v133
    v_add_f32 v130, v130, v134
    v_add_f32 v131, v131, v135
    s_nop 0
    v_permlane32_swap_b32 v128, v130
    v_permlane32_swap_b32 v129, v131
    v_add_f32 v128, v128, v130
    v_add_f32 v129, v129, v131
    s_barrier
    v_mov_b32_dpp v130, v128 row_shl:4 row_mask:0xf bank_mask:0xf
    v_mov_b32_dpp v131, v129 row_shl:4 row_mask:0xf bank_mask:0xf
    v_mul_f32 v128, 0xba800000, v128
    v_mul_f32 v130, 0x3a800000, v130
    v_mul_f32 v129, 0xba800000, v129
    v_mul_f32 v131, 0x3a800000, v131
    v_fma_f32 v130, -v128, v128, v130
    v_fma_f32 v131, -v129, v129, v131
    v_max_f32 v130, 0, v130
    v_max_f32 v131, 0, v131
    v_add_f32 v130, 0x3727c5ac, v130
    v_add_f32 v131, 0x3727c5ac, v131
    v_rsq_f32 v130, v130
    v_rsq_f32 v131, v131
    s_mov_b32 exec_lo, 0x0f0f0f0f
    s_mov_b32 exec_hi, 0x0f0f0f0f
    ds_write_b64 v12, v[128:129]
    ds_write_b64 v12, v[130:131] offset:512
    s_mov_b64 exec, -1
    s_cmp_lt_u32 s51, 2
    s_cbranch_scc0 L_skip_119
    s_mov_b32 s60, 0
    s_branch L_chk_121
L_spin_120:
    s_add_u32 s52, s68, 0
    buffer_load_dwordx4 v[160:163], v15, s[24:27], s52 offen offset:0 sc1
    s_add_u32 s52, s68, 0
    buffer_load_dwordx4 v[164:167], v15, s[24:27], s52 offen offset:2048 sc1
    s_add_u32 s52, s68, 4096
    buffer_load_dwordx4 v[168:171], v15, s[24:27], s52 offen offset:0 sc1
    s_add_u32 s52, s68, 4096
    buffer_load_dwordx4 v[172:175], v15, s[24:27], s52 offen offset:2048 sc1
    s_add_u32 s52, s68, 8192
    buffer_load_dwordx4 v[176:179], v15, s[24:27], s52 offen offset:0 sc1
    s_add_u32 s52, s68, 8192
    buffer_load_dwordx4 v[180:183], v15, s[24:27], s52 offen offset:2048 sc1
    s_add_u32 s52, s68, 12288
    buffer_load_dwordx4 v[184:187], v15, s[24:27], s52 offen offset:0 sc1
    s_add_u32 s52, s68, 12288
    buffer_load_dwordx4 v[188:191], v15, s[24:27], s52 offen offset:2048 sc1
    s_add_u32 s60, s60, 1
    s_cmp_lt_u32 s60, 300000
    s_cbranch_scc0 L_tmo_122
    s_waitcnt vmcnt(0)
L_chk_121:
    v_max_u32 v2, v160, v161
    v_max3_u32 v2, v2, v162, v163
    v_max3_u32 v2, v2, v164, v165
    v_max3_u32 v2, v2, v166, v167
    v_max3_u32 v2, v2, v168, v169
    v_max3_u32 v2, v2, v170, v171
    v_max3_u32 v2, v2, v172, v173
    v_max3_u32 v2, v2, v174, v175
    v_max_u32 v3, v176, v177
    v_max3_u32 v3, v3, v178, v179
    v_max3_u32 v3, v3, v180, v181
    v_max3_u32 v3, v3, v182, v183
    v_max3_u32 v3, v3, v184, v185
    v_max3_u32 v3, v3, v186, v187
    v_max3_u32 v3, v3, v188, v189
    v_max3_u32 v3, v3, v190, v191
    v_max_u32 v2, v2, v3
    v_cmp_eq_u32 vcc, -1, v2
    s_cbranch_vccnz L_spin_120
L_done_124:
L_skip_119:
    s_barrier
    s_cmp_lt_u32 s51, 2
    s_cbranch_scc0 L_skip_125
    v_add_f32 v160, v160, v176
    v_add_f32 v161, v161, v177
    v_add_f32 v162, v162, v178
    v_add_f32 v163, v163, v179
    v_add_f32 v164, v164, v180
    v_add_f32 v165, v165, v181
    v_add_f32 v166, v166, v182
    v_add_f32 v167, v167, v183
    v_add_f32 v168, v168, v184
    v_add_f32 v169, v169, v185
    v_add_f32 v170, v170, v186
    v_add_f32 v171, v171, v187
    v_add_f32 v172, v172, v188
    v_add_f32 v173, v173, v189
    v_add_f32 v174, v174, v190
    v_add_f32 v175, v175, v191
    v_add_f32 v160, v160, v168
    v_add_f32 v161, v161, v169
    v_add_f32 v162, v162, v170
    v_add_f32 v163, v163, v171
    v_add_f32 v164, v164, v172
    v_add_f32 v165, v165, v173
    v_add_f32 v166, v166, v174
    v_add_f32 v167, v167, v175
    v_add_f32 v160, v160, v164
    v_add_f32 v161, v161, v165
    v_add_f32 v162, v162, v166
    v_add_f32 v163, v163, v167
    s_nop 0
    v_permlane32_swap_b32 v160, v162
    v_permlane32_swap_b32 v161, v163
    v_add_f32 v160, v160, v162
    v_add_f32 v161, v161, v163
    s_mul_i32 s52, s51, 768
    v_add_u32 v2, s52, v13
    s_mov_b32 exec_lo, 0xffffff
    s_mov_b32 exec_hi, 0xffffff
    ds_write_b64 v2, v[160:161]
    s_mov_b64 exec, -1
L_skip_125:
    s_waitcnt lgkmcnt(0)
    s_barrier
    s_lshl_b32 s53, s51, 13
    s_lshl_b32 s61, s48, 8
    s_add_u32 s53, s53, s61
    s_lshl_b32 s61, s49, 4
    s_add_u32 s53, s53, s61
    s_lshl_b32 s61, s65, 12
    s_add_u32 s53, s53, s61
    s_lshl_b32 s53, s53, 0
    v_and_b32 v2, 3, v1
    v_lshlrev_b32 v2, 2, v2
    buffer_load_dword v20, v2, s[24:27], s53 offen sc1
    s_lshl_b32 s52, s51, 13
    s_lshl_b32 s61, s48, 8
    s_add_u32 s52, s52, s61
    s_lshl_b32 s61, s95, 4
    s_add_u32 s52, s52, s61
    s_xor_b32 s52, s52, 128
    s_lshl_b32 s70, s52, 5
    s_lshl_b32 s61, s65, 8
    s_add_u32 s70, s70, s61
    s_add_u32 s70, s70, 0x700000
    s_bitcmp0_b32 s51, 0
    s_cselect_b64 s[32:33], s[14:15], s[6:7]
    s_cselect_b64 s[36:37], s[16:17], s[10:11]
    s_and_b32 s56, s48, 3
    s_lshl_b32 s56, s56, 1
    s_add_u32 s56, s56, s65
    s_lshr_b32 s55, s32, 7
    s_sub_u32 s55, 3, s55
    s_and_b32 s55, s55, 7
    s_sub_u32 s54, s49, s55
    s_and_b32 s54, s54, 7
    s_sub_u32 s54, s54, 1
    s_and_b32 s52, s49, 8
    s_add_u32 s55, s55, s52
    s_lshl_b32 s55, s55, 7
    s_bfe_u32 s52, s55, 0x30007
    s_lshl_b32 s61, s52, 2
    s_lshl_b32 s72, 0x11111110, s61
    s_add_u32 s72, s72, 0x65432100
    s_or_b32 s72, s72, s52
    s_lshr_b32 s61, s48, 2
    s_mul_i32 s73, s61, 0x22222222
    s_add_u32 s73, s73, 0x76543210
    s_or_b32 s73, s73, 0x88888888
    s_mov_b32 s61, s95
    s_mul_i32 s61, s61, 0x11111111
    s_xor_b32 s72, s72, s61
    s_xor_b32 s73, s73, s61
    s_cmp_ge_u32 s54, 3
    s_cselect_b32 s52, 190464, 0
    s_add_u32 s55, s55, s52
    s_lshl_b32 s52, s54, 11
    s_add_u32 s55, s55, s52
    s_mul_i32 s52, s56, 24576
    s_add_u32 s55, s55, s52
    s_cmp_lt_u32 s54, 6
    s_cselect_b32 s52, 4, 0
    v_mul_u32_u24 v18, 6144, v1
    v_add_u32 v18, s55, v18
    v_mov_b32 v2, 1073741824
    v_cmp_gt_u32 vcc, s52, v1
    s_nop 1
    v_cndmask_b32 v18, v2, v18, vcc
    s_lshr_b32 s55, s36, 7
    s_sub_u32 s55, 3, s55
    s_and_b32 s55, s55, 7
    s_sub_u32 s54, s49, s55
    s_and_b32 s54, s54, 7
    s_sub_u32 s54, s54, 1
    s_and_b32 s52, s49, 8
    s_add_u32 s55, s55, s52
    s_lshl_b32 s55, s55, 7
    s_lshl_b32 s52, s54, 19
    s_add_u32 s55, s55, s52
    s_mul_i32 s52, s56, 65536
    s_add_u32 s55, s55, s52
    s_cmp_lt_u32 s54, 4
    s_cselect_b32 s52, 8, 0
    s_cselect_b32 s71, s55, -1
    v_lshlrev_b32 v19, 11, v1
    v_add_u32 v19, s55, v19
    v_cmp_gt_u32 vcc, s52, v1
    s_nop 1
    v_cndmask_b32 v19, v2, v19, vcc
    s_bfe_u32 s66, s72, 0x40000
    s_mul_i32 s66, s66, 393216
    buffer_load_dword v20, v18, s[32:35], s66 offen
    s_bfe_u32 s66, s72, 0x40004
    s_mul_i32 s66, s66, 393216
    buffer_load_dword v20, v18, s[32:35], s66 offen
    s_bfe_u32 s66, s72, 0x40008
    s_mul_i32 s66, s66, 393216
    buffer_load_dword v20, v18, s[32:35], s66 offen
    s_bitcmp1_b32 s51, 0
    s_cbranch_scc1 L_hp_B
    s_lshl_b32 s52, s51, 5
    s_lshl_b32 s61, s49, 2
    s_add_u32 s52, s52, s61
    s_add_u32 s52, s52, s50
    s_sub_u32 s52, s52, 0x4
    s_lshl_b32 s80, s52, 15
    s_lshl_b32 s61, s48, 7
    s_add_u32 s80, s80, s61
    s_add_u32 s80, s80, 0x800000
    s_add_u32 s81, s80, 16384
    s_lshl_b32 s83, s52, 11
    s_lshl_b32 s61, s48, 7
    s_add_u32 s83, s83, s61
    s_add_u32 s83, s83, 0x600000
    s_lshl_b32 s82, s52, 10
    s_add_u32 s82, s82, 0x680000
    s_lshl_b32 s84, s52, 6
    s_add_u32 s84, s84, 0x6c0000
    s_and_b32 s52, s52, 1
    s_xor_b32 s53, s48, s49
    s_or_b32 s52, s52, s53
    s_cselect_b32 s82, 1073741824, s82
    s_cselect_b32 s84, 1073741824, s84
    v_and_b32 v203, 7, v1
    v_lshlrev_b32 v203, 4, v203
    v_lshrrev_b32 v204, 3, v1
    v_lshl_add_u32 v200, v204, 11, v203
    v_lshlrev_b32 v201, 4, v1
    v_lshrrev_b32 v204, 4, v1
    v_lshl_add_u32 v202, v204, 2, v203
    s_cmp_eq_u32 s51, 0
    s_cbranch_scc0 L_skip_126
    v_mov_b32 v208, -1
    v_mov_b32 v209, -1
    v_mov_b32 v210, -1
    v_mov_b32 v211, -1
    s_lshl_b32 s52, s49, 17
    s_lshl_b32 s61, s50, 15
    s_add_u32 s52, s52, s61
    s_lshl_b32 s61, s48, 11
    s_add_u32 s52, s52, s61
    s_add_u32 s52, s52, 0x9e0000
    buffer_store_dwordx4 v[208:211], v201, s[24:27], s52 offen sc1
    buffer_store_dwordx4 v[208:211], v201, s[24:27], s52 offen offset:1024 sc1
    s_lshr_b32 s53, s50, 1
    s_and_b32 s54, s50, 1
    s_lshl_b32 s52, s54, 20
    s_lshl_b32 s61, s48, 16
    s_add_u32 s52, s52, s61
    s_lshl_b32 s61, s49, 12
    s_add_u32 s52, s52, s61
    s_lshl_b32 s61, s53, 11
    s_add_u32 s52, s52, s61
    s_add_u32 s52, s52, 0x3ff000
    buffer_store_dwordx4 v[208:211], v201, s[24:27], s52 offen sc1
    buffer_store_dwordx4 v[208:211], v201, s[24:27], s52 offen offset:1024 sc1
    s_lshl_b32 s52, s50, 18
    s_lshl_b32 s61, s48, 14
    s_add_u32 s52, s52, s61
    s_lshl_b32 s61, s49, 10
    s_add_u32 s52, s52, s61
    s_add_u32 s52, s52, 0x140000
    s_lshl_b32 s55, s49, 14
    s_lshl_b32 s61, s48, 10
    s_add_u32 s55, s55, s61
    s_add_u32 s55, s55, 0x340000
    s_cmp_eq_u32 s50, 7
    s_cselect_b32 s52, s55, s52
    buffer_store_dwordx4 v[208:211], v201, s[24:27], s52 offen sc1
    s_mov_b64 exec, 0xff
    s_add_u32 s52, s83, 131072
    buffer_store_dwordx4 v[208:211], v201, s[24:27], s52 offen sc1
    s_add_u32 s52, s84, 4096
    buffer_store_dwordx4 v[208:211], v201, s[24:27], s52 offen sc1
    s_lshl_b32 s52, s49, 12
    s_lshl_b32 s61, s53, 11
    s_add_u32 s52, s52, s61
    s_lshl_b32 s61, s48, 7
    s_add_u32 s52, s52, s61
    s_add_u32 s52, s52, 0x68f000
    buffer_store_dwordx4 v[208:211], v201, s[24:27], s52 offen sc1
    s_mov_b64 exec, -1
    s_waitcnt vmcnt(0)
L_skip_126:
    s_barrier
    s_setprio 3
    s_barrier
    s_mov_b32 s60, 0
L_spin_127:
    buffer_load_dwordx4 v[208:211], v200, s[24:27], s80 offen sc1
    buffer_load_dwordx4 v[212:215], v200, s[24:27], s81 offen sc1
    buffer_load_dwordx4 v[216:219], v201, s[24:27], s82 offen sc1
    buffer_load_dwordx4 v[220:223], v201, s[24:27], s82 offen offset:1024 sc1
    s_add_u32 s60, s60, 1
    s_cmp_lt_u32 s60, 300000
    s_cbranch_scc0 L_tmo_129
    s_waitcnt vmcnt(3)
    v_max_u32 v203, v208, v209
    v_max3_u32 v203, v203, v210, v211
    s_waitcnt vmcnt(2)
    v_max3_u32 v203, v203, v212, v213
    v_max3_u32 v203, v203, v214, v215
    s_waitcnt vmcnt(1)
    v_max_u32 v204, v216, v217
    v_max3_u32 v204, v204, v218, v219
    s_waitcnt vmcnt(0)
    v_max3_u32 v204, v204, v220, v221
    v_max3_u32 v204, v204, v222, v223
    v_max_u32 v203, v203, v204
    v_cmp_eq_u32 vcc, -1, v203
    s_cbranch_vccnz L_spin_127
L_done_131:
    v_lshlrev_b32 v160, 16, v208
    v_and_b32 v161, 0xffff0000, v208
    v_lshlrev_b32 v162, 16, v209
    v_and_b32 v163, 0xffff0000, v209
    v_lshlrev_b32 v164, 16, v210
    v_and_b32 v165, 0xffff0000, v210
    v_lshlrev_b32 v166, 16, v211
    v_and_b32 v167, 0xffff0000, v211
    v_lshlrev_b32 v168, 16, v212
    v_and_b32 v169, 0xffff0000, v212
    v_lshlrev_b32 v170, 16, v213
    v_and_b32 v171, 0xffff0000, v213
    v_lshlrev_b32 v172, 16, v214
    v_and_b32 v173, 0xffff0000, v214
    v_lshlrev_b32 v174, 16, v215
    v_and_b32 v175, 0xffff0000, v215
    v_lshlrev_b32 v176, 16, v216
    v_and_b32 v177, 0xffff0000, v216
    v_lshlrev_b32 v178, 16, v217
    v_and_b32 v179, 0xffff0000, v217
    v_lshlrev_b32 v180, 16, v218
    v_and_b32 v181, 0xffff0000, v218
    v_lshlrev_b32 v182, 16, v219
    v_and_b32 v183, 0xffff0000, v219
    v_lshlrev_b32 v184, 16, v220
    v_and_b32 v185, 0xffff0000, v220
    v_lshlrev_b32 v186, 16, v221
    v_and_b32 v187, 0xffff0000, v221
    v_lshlrev_b32 v188, 16, v222
    v_and_b32 v189, 0xffff0000, v222
    v_lshlrev_b32 v190, 16, v223
    v_and_b32 v191, 0xffff0000, v223
    v_pk_add_f32 v[160:161], v[160:161], v[168:169]
    v_pk_add_f32 v[162:163], v[162:163], v[170:171]
    v_pk_add_f32 v[164:165], v[164:165], v[172:173]
    v_pk_add_f32 v[166:167], v[166:167], v[174:175]
    v_pk_add_f32 v[176:177], v[176:177], v[184:185]
    v_pk_add_f32 v[178:179], v[178:179], v[186:187]
    v_pk_add_f32 v[180:181], v[180:181], v[188:189]
    v_pk_add_f32 v[182:183], v[182:183], v[190:191]
    v_permlane32_swap_b32 v160, v164
    v_permlane32_swap_b32 v161, v165
    v_permlane32_swap_b32 v162, v166
    v_permlane32_swap_b32 v163, v167
    v_permlane32_swap_b32 v176, v180
    v_permlane32_swap_b32 v177, v181
    v_permlane32_swap_b32 v178, v182
    v_permlane32_swap_b32 v179, v183
    v_pk_add_f32 v[160:161], v[160:161], v[164:165]
    v_pk_add_f32 v[162:163], v[162:163], v[166:167]
    v_pk_add_f32 v[176:177], v[176:177], v[180:181]
    v_pk_add_f32 v[178:179], v[178:179], v[182:183]
    v_permlane16_swap_b32 v160, v162
    v_permlane16_swap_b32 v161, v163
    v_permlane16_swap_b32 v176, v178
    v_permlane16_swap_b32 v177, v179
    v_pk_add_f32 v[160:161], v[160:161], v[162:163]
    v_pk_add_f32 v[176:177], v[176:177], v[178:179]
    s_nop 0
    v_add_f32_dpp v160, v160, v160 row_ror:8 row_mask:0xf bank_mask:0xf
    v_add_f32_dpp v161, v161, v161 row_ror:8 row_mask:0xf bank_mask:0xf
    v_add_f32_dpp v176, v176, v176 row_ror:8 row_mask:0xf bank_mask:0xf
    v_add_f32_dpp v177, v177, v177 row_ror:8 row_mask:0xf bank_mask:0xf
    v_cvt_pk_bf16_f32 v160, v160, v161
    v_cvt_pk_bf16_f32 v176, v176, v177
    s_mov_b32 exec_lo, 0x00ff00ff
    s_mov_b32 exec_hi, 0x00ff00ff
    buffer_store_dword v160, v202, s[24:27], s83 offen sc1
    buffer_store_dword v176, v202, s[24:27], s84 offen sc1
    s_mov_b64 exec, -1
    s_setprio 0
    s_waitcnt vmcnt(0)
    s_barrier
    s_branch L_hp_join
L_hp_B:
L_hp_join:
    s_barrier
    s_cmp_eq_u32 s51, 3
    s_cbranch_scc1 L_fin
    s_cmp_eq_u32 s91, 12
    s_cbranch_scc0 L_skip_132
    s_sub_u32 s52, s42, 2048
    s_min_u32 s52, s52, s90
    s_buffer_load_dwordx2 s[88:89], s[40:43], s52 offset:60
    s_buffer_load_dwordx2 s[88:89], s[40:43], s52 offset:188
    s_buffer_load_dwordx2 s[88:89], s[40:43], s52 offset:316
    s_buffer_load_dwordx2 s[88:89], s[40:43], s52 offset:444
    s_buffer_load_dwordx2 s[88:89], s[40:43], s52 offset:572
    s_buffer_load_dwordx2 s[88:89], s[40:43], s52 offset:700
    s_buffer_load_dwordx2 s[88:89], s[40:43], s52 offset:828
    s_buffer_load_dwordx2 s[88:89], s[40:43], s52 offset:956
    s_buffer_load_dwordx2 s[88:89], s[40:43], s52 offset:1084
    s_buffer_load_dwordx2 s[88:89], s[40:43], s52 offset:1212
    s_buffer_load_dwordx2 s[88:89], s[40:43], s52 offset:1340
    s_buffer_load_dwordx2 s[88:89], s[40:43], s52 offset:1468
    s_buffer_load_dwordx2 s[88:89], s[40:43], s52 offset:1596
    s_buffer_load_dwordx2 s[88:89], s[40:43], s52 offset:1724
    s_buffer_load_dwordx2 s[88:89], s[40:43], s52 offset:1852
    s_buffer_load_dwordx2 s[88:89], s[40:43], s52 offset:1980
    s_add_u32 s90, s90, 2048
L_skip_132:
    s_add_u32 s70, s70, 131072
    s_add_u32 s51, s51, 1
    s_barrier
    s_bfe_u32 s66, s72, 0x4000c
    s_mul_i32 s66, s66, 393216
    buffer_load_dword v20, v18, s[32:35], s66 offen
    s_bfe_u32 s66, s72, 0x40010
    s_mul_i32 s66, s66, 393216
    buffer_load_dword v20, v18, s[32:35], s66 offen
    s_branch L_hp_layer
L_fin:
    s_waitcnt vmcnt(0)
L_end:
    s_endpgm
L_tmo_5:
    s_waitcnt vmcnt(0) lgkmcnt(0)
    v_mov_b32 v196, 32
    buffer_atomic_or v196, off, s[44:47], 0 offset:4 sc1
    s_branch L_done_7
L_hg_8:
    v_subrev_u32 v234, 8, v234
    ds_read_b32 v157, v234
    ds_read_b128 v[136:139], v252 offset:0
    ds_read_b128 v[140:143], v252 offset:1024
    s_branch L_hd_9
L_tmo_14:
    s_waitcnt vmcnt(0) lgkmcnt(0)
    v_mov_b32 v156, 1
    buffer_atomic_or v156, off, s[44:47], 0 offset:4 sc1
    s_branch L_done_16
L_tmo_19:
    s_waitcnt vmcnt(0) lgkmcnt(0)
    v_mov_b32 v156, 4096
    buffer_atomic_or v156, off, s[44:47], 0 offset:4 sc1
    s_branch L_done_21
L_hu_10:
    s_mov_b32 s60, 0
    s_branch L_chk_18
L_spin_17:
    ds_read_b32 v157, v234
    ds_read_b128 v[136:139], v252 offset:0
    ds_read_b128 v[140:143], v252 offset:1024
    s_add_u32 s60, s60, 1
    s_cmp_lt_u32 s60, 300000
    s_cbranch_scc0 L_tmo_19
    s_waitcnt vmcnt(0)
L_chk_18:
    s_waitcnt lgkmcnt(0)
    v_mfma_f32_16x16x32_bf16 v[36:39], v[136:139], v[32:35], v[244:247]
    v_cmp_ne_u32 vcc, v235, v157
    s_cbranch_vccnz L_spin_17
L_done_21:
    s_branch L_hv_11
L_alt_25:
    s_mov_b32 s60, 0
L_spin_27:
    buffer_load_dword v197, v196, s[24:27], s84 offen sc1
    s_add_u32 s60, s60, 1
    s_cmp_lt_u32 s60, 300000
    s_cbranch_scc0 L_tmo_24
    s_waitcnt vmcnt(0) lgkmcnt(0)
    v_cmp_eq_u32 vcc, 0, v197
    s_cbranch_vccnz L_spin_27
    s_branch L_done_26
L_tmo_24:
    s_waitcnt vmcnt(0) lgkmcnt(0)
    v_mov_b32 v197, 16
    buffer_atomic_or v197, off, s[44:47], 0 offset:4 sc1
    s_branch L_done_26
L_alt_32:
    s_mov_b32 s60, 0
L_spin_34:
    s_sleep 1
    buffer_load_dword v198, v204, s[24:27], s83 offen sc1
    s_add_u32 s60, s60, 1
    s_cmp_lt_u32 s60, 300000
    s_cbranch_scc0 L_tmo_31
    s_waitcnt vmcnt(0)
    v_cmp_eq_u32 vcc, 0, v198
    s_cbranch_vccnz L_spin_34
    s_branch L_done_33
L_tmo_31:
    s_waitcnt vmcnt(0)
    v_mov_b32 v198, 512
    buffer_atomic_or v198, off, s[44:47], 0 offset:4 sc1
    s_branch L_done_33
L_tmo_48:
    s_waitcnt vmcnt(0) lgkmcnt(0)
    v_mov_b32 v203, 2
    buffer_atomic_or v203, off, s[44:47], 0 offset:4 sc1
    s_branch L_done_50
L_alt_56:
    s_mov_b32 s60, 0
L_spin_58:
    buffer_load_dword v2, v5, s[24:27], s76 offen sc1
    s_add_u32 s60, s60, 1
    s_cmp_lt_u32 s60, 300000
    s_cbranch_scc0 L_tmo_55
    s_waitcnt vmcnt(0) lgkmcnt(0)
    v_cmp_eq_u32 vcc, 0, v2
    s_cbranch_vccnz L_spin_58
    s_branch L_done_57
L_tmo_55:
    s_waitcnt vmcnt(0) lgkmcnt(0)
    v_mov_b32 v2, 4
    buffer_atomic_or v2, off, s[44:47], 0 offset:4 sc1
    s_branch L_done_57
L_tmo_76:
    s_waitcnt vmcnt(0) lgkmcnt(0)
    v_mov_b32 v22, 256
    buffer_atomic_or v22, off, s[44:47], 0 offset:4 sc1
    s_branch L_done_78
L_tmo_100:
    s_waitcnt vmcnt(0) lgkmcnt(0)
    v_mov_b32 v5, 8
    buffer_atomic_or v5, off, s[44:47], 0 offset:4 sc1
    s_branch L_done_102
L_tmo_116:
    s_waitcnt vmcnt(0) lgkmcnt(0)
    v_mov_b32 v2, 64
    buffer_atomic_or v2, off, s[44:47], 0 offset:4 sc1
    s_branch L_done_118
L_tmo_122:
    s_waitcnt vmcnt(0) lgkmcnt(0)
    v_mov_b32 v2, 128
    buffer_atomic_or v2, off, s[44:47], 0 offset:4 sc1
    s_branch L_done_124
L_tmo_129:
    s_waitcnt vmcnt(0) lgkmcnt(0)
    v_mov_b32 v203, 2
    buffer_atomic_or v203, off, s[44:47], 0 offset:4 sc1
    s_branch L_done_131
.section .rodata,"a"
.p2align 6
.amdhsa_kernel interleave_layers__linear_kernel_hedgehog__sliding_local_dilated__prompt_kernel
  .amdhsa_next_free_vgpr 256
  .amdhsa_next_free_sgpr 96
  .amdhsa_accum_offset 256
  .amdhsa_group_segment_fixed_size 0
  .amdhsa_kernarg_size 80
  .amdhsa_user_sgpr_count 2
  .amdhsa_user_sgpr_kernarg_segment_ptr 1
  .amdhsa_system_sgpr_workgroup_id_x 1
  .amdhsa_float_denorm_mode_32 3
.end_amdhsa_kernel
```
